```python
import torch

def _softmax(x, axis=-1):
    return torch.softmax(x, dim=axis)
def _gelu(x):
    return torch.nn.functional.gelu(x, approximate="tanh")
def _silu(x):
    return torch.nn.functional.silu(x)
def _sigmoid(x):
    return torch.sigmoid(x)
def _layernorm(x, axis=-1, eps=1e-5):
    m = x.mean(dim=axis, keepdim=True)
    v = x.var(dim=axis, keepdim=True, unbiased=False)
    return (x - m) / torch.sqrt(v + eps)
def _scatter_add(tgt, idx, src, axis=0):
    return tgt.clone().index_add_(axis, idx, src)
def _segment_sum(src, seg, n):
    out = torch.zeros((n,) + src.shape[1:], dtype=src.dtype)
    return out.index_add_(0, seg, src)
def _pad(x, pw):
    flat = tuple(v for pair in reversed(pw) for v in pair)
    return torch.nn.functional.pad(x, flat)

kernel_name = 'gather_scatter__edge_featured_mpnn_gatedgcn__graph'

def setup_inputs():

    _w = (lambda a: (lambda t: t.to(torch.bfloat16) if t.is_floating_point() else t)(torch.as_tensor(a)))
    N, deg, D, De = 12500, 32, 128, max(4, 1)
    E = N * deg
    return {
        "x": _w((lambda *s: torch.randn(*s, dtype=torch.bfloat16) * 0.4)(N, D)),
        "e_attr": _w((lambda *s: torch.randn(*s, dtype=torch.bfloat16) * 0.8)(E, De)),
        "src": _w((lambda lo, hi, *s: torch.randint(lo, hi, s))(0, N, E).to(torch.int64)),
        "dst": _w((lambda lo, hi, *s: torch.randint(lo, hi, s))(0, N, E).to(torch.int64)),
        "w_a": _w((lambda *s: torch.randn(*s, dtype=torch.bfloat16) * 0.4)(D, D)),
        "w_b": _w((lambda *s: torch.randn(*s, dtype=torch.bfloat16) * 0.4)(D, D)),
        "w_c": _w((lambda *s: torch.randn(*s, dtype=torch.bfloat16) * 0.8)(De, D)),
        "w_u": _w((lambda *s: torch.randn(*s, dtype=torch.bfloat16) * 0.05)(D, D)),
        "w_v": _w((lambda *s: torch.randn(*s, dtype=torch.bfloat16) * 0.05)(D, D)),
    }

def reference(x, e_attr, src, dst, w_a, w_b, w_c, w_u, w_v):
    N, D = x.shape
    hv = x @ w_v
    g = x[dst] @ w_a + x[src] @ w_b + e_attr @ w_c
    eta = _sigmoid(g)
    denom = _segment_sum(eta, dst, N) + 1e-6
    eta_n = eta / denom[dst]
    agg = _segment_sum(eta_n * hv[src], dst, N)
    z = x @ w_u + agg
    relu_z = torch.where(z > 0, z, 0 * z)
    return x + relu_z
```

```asm
; @launch kernel=gk2_kernel grid=(758,1,1) block=(512,1,1) lds=53040
.amdgcn_target "amdgcn-amd-amdhsa--gfx950"
.text
.globl gk2_kernel
.p2align 8
.type gk2_kernel,@function
gk2_kernel:
    s_sub_u32 s3, s2, 128
    s_cmp_ge_u32 s3, 16
    s_cbranch_scc1 K2_ncp
    s_getpc_b64 s[40:41]
K2_pc:
    s_mov_b32 s42, K2_end-K2_pc
    s_mov_b32 s43, 0x00020000
    v_lshlrev_b32 v79, 6, v0
    buffer_load_dword v79, v79, s[40:43], 0 offen
K2_ncp:
    s_cmp_ge_u32 s2, 758
    s_cbranch_scc1 K2_done0
    s_cmp_ge_u32 s2, 256
    s_cbranch_scc1 K2_start0
    s_setprio 3
    s_load_dwordx16 s[4:19], s[0:1], 0
    s_load_dwordx8 s[20:27], s[0:1], 64
    s_memrealtime s[76:77]
    s_cmp_ge_u32 s2, 128
    s_cbranch_scc1 KG
KP:
    v_lshlrev_b32 v1, 3, v0
    v_lshlrev_b32 v2, 2, v0
    v_mov_b32 v4, 0
    ds_write_b32 v2, v4
    s_mul_i32 s3, s2, 12500
    s_lshl_b32 s28, s3, 1
    s_waitcnt lgkmcnt(0)
    s_add_u32 s32, s10, s3
    s_addc_u32 s33, s11, 0
    s_mov_b32 s34, 12500
    s_mov_b32 s35, 0x00020000
    s_add_u32 s36, s8, s3
    s_addc_u32 s37, s9, 0
    s_mov_b32 s38, 12500
    s_mov_b32 s39, 0x00020000
    s_add_u32 s64, s6, s28
    s_addc_u32 s65, s7, 0
    s_mov_b32 s66, 25000
    s_mov_b32 s67, 0x00020000
    v_lshlrev_b32 v3, 4, v0
    s_movk_i32 s56, 0
    s_movk_i32 s57, 4096
    s_movk_i32 s58, 8192
    s_movk_i32 s59, 12288
    s_movk_i32 s72, 0
    s_movk_i32 s73, 8192
    s_movk_i32 s74, 16384
    s_movk_i32 s75, 24576
    s_mov_b32 s68, s24
    s_mov_b32 s69, s25
    s_mov_b32 s70, 0x100
    s_mov_b32 s71, 0x00020000
    buffer_load_dwordx2 v[44:45], v1, s[32:35], s56 offen nt
    buffer_load_dwordx2 v[46:47], v1, s[32:35], s57 offen nt
    buffer_load_dwordx2 v[48:49], v1, s[32:35], s58 offen nt
    buffer_load_dword v50, v2, s[32:35], s59 offen nt
    s_barrier
    buffer_load_dwordx4 v[16:19], v3, s[64:67], s72 offen nt
    buffer_load_dwordx4 v[20:23], v3, s[64:67], s73 offen nt
    buffer_load_dwordx4 v[24:27], v3, s[64:67], s74 offen nt
    buffer_load_dwordx2 v[28:29], v1, s[64:67], s75 offen nt
    buffer_load_dwordx2 v[52:53], v1, s[36:39], s56 offen nt
    buffer_load_dwordx2 v[54:55], v1, s[36:39], s57 offen nt
    buffer_load_dwordx2 v[56:57], v1, s[36:39], s58 offen nt
    buffer_load_dword v58, v2, s[36:39], s59 offen nt
    s_mov_b32 s40, s26
    s_mov_b32 s41, s27
    s_mov_b32 s42, 0x1000000
    s_mov_b32 s43, 0x00020000
    s_lshr_b32 s76, s76, 10
    s_mul_i32 s76, s76, 0x9e3779b1
    s_lshr_b32 vcc_lo, s76, 15
    s_xor_b32 s76, s76, vcc_lo
    s_mul_i32 s76, s76, 0x85ebca6b
    s_and_b32 s76, s76, 0xf0000000
    s_lshr_b32 s76, s76, 4
    s_add_u32 s40, s40, s76
    s_addc_u32 s41, s41, 0
    v_subrev_u32 v78, 496, v0
    v_lshlrev_b32 v78, 20, v78
    buffer_load_dword v79, v78, s[40:43], 0 offen sc1
    s_mov_b32 s40, s22
    s_mov_b32 s41, s23
    s_mov_b32 s42, 0x30d400
    s_mov_b32 s43, 0x00020000
    buffer_load_dword v79, v78, s[40:43], 0 offen sc1
    s_mul_i32 s29, s2, 37504
    s_add_u32 s29, s29, 0x900000
    s_add_u32 s44, s26, s29
    s_addc_u32 s45, s27, 0
    s_mov_b32 s46, 37504
    s_mov_b32 s47, 0x00020000
    s_add_u32 s48, s26, 0x800000
    s_addc_u32 s49, s27, 0
    s_mov_b32 s50, 0x80000
    s_mov_b32 s51, 0x00020000
    v_mov_b32 v6, 1
    v_cmp_gt_u32 s[30:31], 53, v0
    s_mov_b32 s52, 61681
    s_movk_i32 s53, 34
    v_mov_b32 v13, 0x1800000
    v_mov_b32 v14, -408
    v_lshrrev_b32 v12, 6, v0
    s_nop 0
    v_readfirstlane_b32 s54, v12
    s_waitcnt vmcnt(13)
    v_mad_u32_u24 v37, v44, s52, v13
    v_lshrrev_b32 v7, 5, v44
    v_lshrrev_b32 v37, 21, v37
    v_max_u32 v37, v37, v7
    v_mad_i32_i24 v7, v37, s53, v14
    v_lshlrev_b32 v15, 5, v37
    v_min_i32 v7, v7, v15
    v_sub_u32 v44, v44, v7
    v_lshlrev_b32 v37, 2, v37
    ds_add_rtn_u32 v60, v37, v6
    v_mad_u32_u24 v38, v45, s52, v13
    v_lshrrev_b32 v7, 5, v45
    v_lshrrev_b32 v38, 21, v38
    v_max_u32 v38, v38, v7
    v_mad_i32_i24 v7, v38, s53, v14
    v_lshlrev_b32 v15, 5, v38
    v_min_i32 v7, v7, v15
    v_sub_u32 v45, v45, v7
    v_lshlrev_b32 v38, 2, v38
    ds_add_rtn_u32 v61, v38, v6
    s_waitcnt vmcnt(12)
    v_mad_u32_u24 v39, v46, s52, v13
    v_lshrrev_b32 v7, 5, v46
    v_lshrrev_b32 v39, 21, v39
    v_max_u32 v39, v39, v7
    v_mad_i32_i24 v7, v39, s53, v14
    v_lshlrev_b32 v15, 5, v39
    v_min_i32 v7, v7, v15
    v_sub_u32 v46, v46, v7
    v_lshlrev_b32 v39, 2, v39
    ds_add_rtn_u32 v62, v39, v6
    v_mad_u32_u24 v40, v47, s52, v13
    v_lshrrev_b32 v7, 5, v47
    v_lshrrev_b32 v40, 21, v40
    v_max_u32 v40, v40, v7
    v_mad_i32_i24 v7, v40, s53, v14
    v_lshlrev_b32 v15, 5, v40
    v_min_i32 v7, v7, v15
    v_sub_u32 v47, v47, v7
    v_lshlrev_b32 v40, 2, v40
    ds_add_rtn_u32 v63, v40, v6
    s_waitcnt vmcnt(11)
    v_mad_u32_u24 v41, v48, s52, v13
    v_lshrrev_b32 v7, 5, v48
    v_lshrrev_b32 v41, 21, v41
    v_max_u32 v41, v41, v7
    v_mad_i32_i24 v7, v41, s53, v14
    v_lshlrev_b32 v15, 5, v41
    v_min_i32 v7, v7, v15
    v_sub_u32 v48, v48, v7
    v_lshlrev_b32 v41, 2, v41
    ds_add_rtn_u32 v64, v41, v6
    v_mad_u32_u24 v42, v49, s52, v13
    v_lshrrev_b32 v7, 5, v49
    v_lshrrev_b32 v42, 21, v42
    v_max_u32 v42, v42, v7
    v_mad_i32_i24 v7, v42, s53, v14
    v_lshlrev_b32 v15, 5, v42
    v_min_i32 v7, v7, v15
    v_sub_u32 v49, v49, v7
    v_lshlrev_b32 v42, 2, v42
    ds_add_rtn_u32 v65, v42, v6
    s_waitcnt vmcnt(10)
    v_mad_u32_u24 v43, v50, s52, v13
    v_lshrrev_b32 v7, 5, v50
    v_lshrrev_b32 v43, 21, v43
    v_max_u32 v43, v43, v7
    v_mad_i32_i24 v7, v43, s53, v14
    v_lshlrev_b32 v15, 5, v43
    v_min_i32 v7, v7, v15
    v_sub_u32 v50, v50, v7
    v_lshlrev_b32 v43, 2, v43
    s_mov_b64 exec, s[30:31]
    ds_add_rtn_u32 v66, v43, v6
    s_mov_b64 exec, -1
    v_lshlrev_b32 v30, 18, v44
    v_lshlrev_b32 v31, 18, v45
    v_lshlrev_b32 v32, 18, v46
    v_lshlrev_b32 v33, 18, v47
    v_lshlrev_b32 v34, 18, v48
    v_lshlrev_b32 v35, 18, v49
    v_lshlrev_b32 v36, 18, v50
    s_waitcnt lgkmcnt(0)
    s_barrier
    ds_read_b32 v8, v2
    s_waitcnt lgkmcnt(0)
    v_mov_b32 v11, v8
    s_nop 1
    v_add_u32_dpp v11, v11, v11 row_shr:1 row_mask:0xf bank_mask:0xf bound_ctrl:0
    s_nop 1
    v_add_u32_dpp v11, v11, v11 row_shr:2 row_mask:0xf bank_mask:0xf bound_ctrl:0
    s_nop 1
    v_add_u32_dpp v11, v11, v11 row_shr:4 row_mask:0xf bank_mask:0xf bound_ctrl:0
    s_nop 1
    v_add_u32_dpp v11, v11, v11 row_shr:8 row_mask:0xf bank_mask:0xf bound_ctrl:0
    s_nop 1
    v_add_u32_dpp v11, v11, v11 row_bcast:15 row_mask:0xa bank_mask:0xf
    s_nop 1
    v_add_u32_dpp v11, v11, v11 row_bcast:31 row_mask:0xc bank_mask:0xf
    s_nop 1
    v_readlane_b32 s55, v11, 63
    s_lshl_b32 s63, s54, 2
    s_add_u32 s63, s63, 2048
    v_mov_b32 v13, s63
    v_mov_b32 v14, s55
    s_mov_b64 exec, 1
    ds_write_b32 v13, v14
    s_mov_b64 exec, -1
    s_waitcnt lgkmcnt(0)
    s_barrier
    v_and_b32 v13, 7, v0
    v_lshlrev_b32 v14, 2, v13
    ds_read_b32 v4, v14 offset:2048
    v_sub_u32 v11, v11, v8
    v_cmp_gt_u32 vcc, s54, v13
    s_waitcnt lgkmcnt(0)
    v_cndmask_b32 v4, 0, v4, vcc
    s_nop 1
    v_add_u32_dpp v4, v4, v4 row_shr:1 row_mask:0xf bank_mask:0xf bound_ctrl:0
    s_nop 1
    v_add_u32_dpp v4, v4, v4 row_shr:2 row_mask:0xf bank_mask:0xf bound_ctrl:0
    s_nop 1
    v_add_u32_dpp v4, v4, v4 row_shr:4 row_mask:0xf bank_mask:0xf bound_ctrl:0
    s_nop 1
    v_readlane_b32 s55, v4, 7
    s_nop 1
    v_add_u32 v4, s55, v11
    ds_write_b32 v2, v4
    v_lshl_or_b32 v6, v4, 16, v8
    v_lshlrev_b32 v12, 3, v0
    s_lshl_b32 s63, s2, 12
    s_waitcnt lgkmcnt(0)
    s_barrier
    ds_read_b32 v44, v37
    ds_read_b32 v45, v38
    ds_read_b32 v46, v39
    ds_read_b32 v47, v40
    ds_read_b32 v48, v41
    ds_read_b32 v49, v42
    ds_read_b32 v50, v43
    v_mov_b32 v5, 4096
    s_cmp_lg_u32 s54, 0
    s_cbranch_scc1 KP_w1
    buffer_load_dword v8, off, s[68:71], 0 sc1
    s_waitcnt vmcnt(1)
    s_branch KP_w2
KP_w1:
    s_waitcnt vmcnt(0)
KP_w2:
    v_or_b32 v30, v52, v30
    v_or_b32 v31, v53, v31
    v_or_b32 v32, v54, v32
    v_or_b32 v33, v55, v33
    v_or_b32 v34, v56, v34
    v_or_b32 v35, v57, v35
    v_or_b32 v36, v58, v36
    s_waitcnt lgkmcnt(6)
    v_add_u32 v44, v44, v60
    v_mad_u32_u24 v44, v44, 12, v5
    ds_write2_b32 v44, v16, v17 offset0:0 offset1:1
    ds_write_b32 v44, v30 offset:8
    s_waitcnt lgkmcnt(7)
    v_add_u32 v45, v45, v61
    v_mad_u32_u24 v45, v45, 12, v5
    ds_write2_b32 v45, v18, v19 offset0:0 offset1:1
    ds_write_b32 v45, v31 offset:8
    s_waitcnt lgkmcnt(8)
    v_add_u32 v46, v46, v62
    v_mad_u32_u24 v46, v46, 12, v5
    ds_write2_b32 v46, v20, v21 offset0:0 offset1:1
    ds_write_b32 v46, v32 offset:8
    s_waitcnt lgkmcnt(9)
    v_add_u32 v47, v47, v63
    v_mad_u32_u24 v47, v47, 12, v5
    ds_write2_b32 v47, v22, v23 offset0:0 offset1:1
    ds_write_b32 v47, v33 offset:8
    s_waitcnt lgkmcnt(10)
    v_add_u32 v48, v48, v64
    v_mad_u32_u24 v48, v48, 12, v5
    ds_write2_b32 v48, v24, v25 offset0:0 offset1:1
    ds_write_b32 v48, v34 offset:8
    s_waitcnt lgkmcnt(11)
    v_add_u32 v49, v49, v65
    v_mad_u32_u24 v49, v49, 12, v5
    ds_write2_b32 v49, v26, v27 offset0:0 offset1:1
    ds_write_b32 v49, v35 offset:8
    s_waitcnt lgkmcnt(12)
    v_add_u32 v50, v50, v66
    v_mad_u32_u24 v50, v50, 12, v5
    s_mov_b64 exec, s[30:31]
    ds_write2_b32 v50, v28, v29 offset0:0 offset1:1
    ds_write_b32 v50, v36 offset:8
    s_mov_b64 exec, -1
    v_mov_b32 v9, 52976
    s_cmp_lg_u32 s54, 0
    s_cbranch_scc1 KP_nn
    s_waitcnt vmcnt(0)
    v_readfirstlane_b32 s43, v8
    s_cmp_lg_u32 s43, 0
    s_cbranch_scc1 KG_godP
    s_mov_b32 s3, 0
KG_goP:
    buffer_load_dword v8, off, s[68:71], 0 sc1
    s_waitcnt vmcnt(0)
    v_readfirstlane_b32 s43, v8
    s_cmp_lg_u32 s43, 0
    s_cbranch_scc1 KG_godP
    s_add_u32 s3, s3, 1
    s_cmp_gt_u32 s3, 30000
    s_cbranch_scc1 K2_done0
    s_sleep 1
    s_branch KG_goP
KG_godP:
    ds_write_b32 v9, v8
KP_nn:
    s_waitcnt lgkmcnt(0)
    s_barrier
    ds_read_b32 v7, v9
    ds_read_b128 v[16:19], v3 offset:4096
    ds_read_b128 v[20:23], v3 offset:12288
    ds_read_b128 v[24:27], v3 offset:20480
    ds_read_b128 v[28:31], v3 offset:28672
    ds_read_b128 v[32:35], v3 offset:36864
    s_movk_i32 s56, 0
    s_movk_i32 s57, 8192
    s_movk_i32 s58, 16384
    s_movk_i32 s59, 24576
    s_mov_b32 s60, 32768
    s_waitcnt lgkmcnt(5)
    v_readfirstlane_b32 s43, v7
    s_lshr_b32 s76, s43, 10
    s_mul_i32 s76, s76, 0x9e3779b1
    s_lshr_b32 vcc_lo, s76, 15
    s_xor_b32 s76, s76, vcc_lo
    s_mul_i32 s76, s76, 0x85ebca6b
    s_and_b32 s76, s76, 0xf0000000
    s_lshr_b32 s76, s76, 4
    s_add_u32 s44, s44, s76
    s_addc_u32 s45, s45, 0
    s_add_u32 s48, s48, s76
    s_addc_u32 s49, s49, 0
    s_waitcnt lgkmcnt(4)
    buffer_store_dwordx4 v[16:19], v3, s[44:47], s56 offen sc1
    s_waitcnt lgkmcnt(3)
    buffer_store_dwordx4 v[20:23], v3, s[44:47], s57 offen sc1
    s_waitcnt lgkmcnt(2)
    buffer_store_dwordx4 v[24:27], v3, s[44:47], s58 offen sc1
    s_waitcnt lgkmcnt(1)
    buffer_store_dwordx4 v[28:31], v3, s[44:47], s59 offen sc1
    s_waitcnt lgkmcnt(0)
    buffer_store_dwordx4 v[32:35], v3, s[44:47], s60 offen sc1
    s_waitcnt vmcnt(0) lgkmcnt(0)
    s_barrier
    buffer_store_dwordx2 v[6:7], v12, s[48:51], s63 offen sc1
    s_branch K2_start
KG:
    v_lshrrev_b32 v1, 6, v0
    v_and_b32 v2, 15, v0
    v_bfe_u32 v3, v0, 4, 2
    v_readfirstlane_b32 s54, v1
    v_lshlrev_b32 v10, 4, v0
    s_sub_u32 s52, s2, 128
    s_mul_i32 s53, s52, 25088
    s_add_u32 s55, s53, 25088
    s_min_u32 s55, s55, 3200000
    s_add_u32 s56, s53, 8192
    s_add_u32 s57, s53, 16384
    s_add_u32 s58, s53, 24576
    s_movk_i32 s72, 8192
    s_movk_i32 s73, 16384
    s_movk_i32 s74, 24576
    s_waitcnt lgkmcnt(0)
    s_mov_b32 s32, s14
    s_mov_b32 s33, s15
    s_mov_b32 s34, 0x8000
    s_mov_b32 s35, 0x00020000
    s_mov_b32 s28, s20
    s_mov_b32 s29, s21
    s_mov_b32 s30, 0x8000
    s_mov_b32 s31, 0x00020000
    s_mov_b32 s36, s4
    s_mov_b32 s37, s5
    s_mov_b32 s38, 0x30d400
    s_mov_b32 s39, 0x00020000
    s_mov_b32 s38, s55
    buffer_load_dwordx4 v[16:19], v10, s[32:35], 0 offen
    buffer_load_dwordx4 v[20:23], v10, s[32:35], s72 offen
    buffer_load_dwordx4 v[24:27], v10, s[32:35], s73 offen
    buffer_load_dwordx4 v[28:31], v10, s[32:35], s74 offen
    s_barrier
    buffer_load_dwordx4 v[32:35], v10, s[28:31], 0 offen
    buffer_load_dwordx4 v[36:39], v10, s[28:31], s72 offen
    buffer_load_dwordx4 v[40:43], v10, s[28:31], s73 offen
    buffer_load_dwordx4 v[44:47], v10, s[28:31], s74 offen
    s_barrier
    buffer_load_dwordx4 v[48:51], v10, s[36:39], s53 offen
    buffer_load_dwordx4 v[52:55], v10, s[36:39], s56 offen
    s_barrier
    buffer_load_dwordx4 v[56:59], v10, s[36:39], s57 offen
    buffer_load_dwordx4 v[60:63], v10, s[36:39], s58 offen
    s_mov_b32 s40, s26
    s_mov_b32 s41, s27
    s_mov_b32 s42, 0x1000000
    s_mov_b32 s43, 0x00020000
    s_lshr_b32 s76, s76, 10
    s_mul_i32 s76, s76, 0x9e3779b1
    s_lshr_b32 vcc_lo, s76, 15
    s_xor_b32 s76, s76, vcc_lo
    s_mul_i32 s76, s76, 0x85ebca6b
    s_and_b32 s76, s76, 0xf0000000
    s_lshr_b32 s76, s76, 4
    s_add_u32 s40, s40, s76
    s_addc_u32 s41, s41, 0
    v_subrev_u32 v14, 496, v0
    v_lshlrev_b32 v14, 20, v14
    buffer_load_dword v15, v14, s[40:43], 0 offen sc1
    s_mov_b32 s40, s22
    s_mov_b32 s41, s23
    s_mov_b32 s42, 0x30d400
    s_mov_b32 s43, 0x00020000
    buffer_load_dword v15, v14, s[40:43], 0 offen sc1
    s_mov_b32 s68, s24
    s_mov_b32 s69, s25
    s_mov_b32 s70, 0x100
    s_mov_b32 s71, 0x00020000
    s_mov_b32 s44, s26
    s_mov_b32 s45, s27
    s_mov_b32 s46, 0x61c000
    s_mov_b32 s47, 0x00020000
    s_lshl_b32 s46, s55, 1
    s_add_u32 s64, s26, 0x740000
    s_addc_u32 s65, s27, 0
    s_mov_b32 s66, 0x4000
    s_mov_b32 s67, 0x00020000
    v_and_b32 v11, 0x1f0, v0
    v_add_u32 v11, v11, v10
    v_and_b32 v8, 63, v0
    v_mul_u32_u24 v9, 272, v2
    v_lshl_add_u32 v9, v3, 4, v9
    s_and_b32 s28, s54, 1
    s_lshr_b32 s29, s54, 1
    v_bfe_u32 v5, v0, 7, 1
    v_lshl_or_b32 v5, v5, 2, v3
    v_lshlrev_b32 v5, 5, v5
    v_xor_b32 v1, v10, v5
    v_lshrrev_b32 v4, 2, v2
    v_lshl_add_u32 v7, v3, 3, v4
    v_lshlrev_b32 v7, 8, v7
    v_and_b32 v5, 3, v2
    v_lshl_add_u32 v7, v5, 3, v7
    v_and_b32 v5, 1, v3
    v_lshl_or_b32 v5, v5, 2, v4
    s_lshl_b32 s31, s28, 2
    s_add_u32 s31, s31, s29
    v_xor_b32 v5, s31, v5
    v_lshl_add_u32 v7, v5, 5, v7
    s_lshl_b32 s31, s31, 6
    v_mul_u32_u24 v6, 528, v2
    v_lshl_add_u32 v6, v3, 4, v6
    v_add_u32 v6, s31, v6
    v_lshrrev_b32 v4, 5, v0
    v_lshl_add_u32 v4, v4, 4, v10
    s_lshl_b32 s53, s53, 1
    s_mov_b32 s62, 0xbfb8aa3b
    s_mov_b32 s63, 0xbfb8aa3b
    s_mov_b32 s60, 0x07060100
    s_mov_b32 s61, 0x07060302
    s_mov_b32 s59, 0x80008000
    s_waitcnt vmcnt(11)
    ds_write_b128 v1, v[16:19] offset:0
    s_waitcnt vmcnt(10)
    ds_write_b128 v1, v[20:23] offset:8192
    s_waitcnt vmcnt(9)
    ds_write_b128 v1, v[24:27] offset:16384
    s_waitcnt vmcnt(8)
    ds_write_b128 v1, v[28:31] offset:24576
    s_waitcnt lgkmcnt(0)
    s_barrier
    ds_read_b64_tr_b16 v[64:65], v7 offset:0
    ds_read_b64_tr_b16 v[66:67], v7 offset:1024
    ds_read_b64_tr_b16 v[68:69], v7 offset:8192
    ds_read_b64_tr_b16 v[70:71], v7 offset:9216
    ds_read_b64_tr_b16 v[72:73], v7 offset:16384
    ds_read_b64_tr_b16 v[74:75], v7 offset:17408
    ds_read_b64_tr_b16 v[76:77], v7 offset:24576
    ds_read_b64_tr_b16 v[78:79], v7 offset:25600
    s_waitcnt lgkmcnt(0)
    s_barrier
    s_cmp_lg_u32 s54, 0
    s_cbranch_scc1 KG_w1
    buffer_load_dword v13, off, s[68:71], 0 sc1
KG_w1:
    s_waitcnt vmcnt(7)
    ds_write_b128 v1, v[32:35] offset:0
    s_waitcnt vmcnt(6)
    ds_write_b128 v1, v[36:39] offset:8192
    s_waitcnt vmcnt(5)
    ds_write_b128 v1, v[40:43] offset:16384
    s_waitcnt vmcnt(4)
    ds_write_b128 v1, v[44:47] offset:24576
    s_waitcnt vmcnt(3)
    ds_write_b128 v11, v[48:51] offset:32768
    s_waitcnt vmcnt(2)
    ds_write_b128 v11, v[52:55] offset:41472
    s_waitcnt lgkmcnt(0)
    s_barrier
    ds_read_b64_tr_b16 v[16:17], v7 offset:0
    ds_read_b64_tr_b16 v[18:19], v7 offset:1024
    ds_read_b64_tr_b16 v[20:21], v7 offset:8192
    ds_read_b64_tr_b16 v[22:23], v7 offset:9216
    ds_read_b64_tr_b16 v[24:25], v7 offset:16384
    ds_read_b64_tr_b16 v[26:27], v7 offset:17408
    ds_read_b64_tr_b16 v[28:29], v7 offset:24576
    ds_read_b64_tr_b16 v[30:31], v7 offset:25600
    ds_read_b128 v[32:35], v9 offset:32768
    ds_read_b128 v[36:39], v9 offset:32832
    ds_read_b128 v[40:43], v9 offset:32896
    ds_read_b128 v[44:47], v9 offset:32960
    s_waitcnt lgkmcnt(4)
    s_barrier
    s_waitcnt vmcnt(0)
    ds_write_b128 v11, v[56:59]
    s_cmp_ge_u32 s54, 4
    s_cbranch_scc1 KG_nx
    ds_write_b128 v11, v[60:63] offset:8704
KG_nx:
    v_mov_b32 v7, 52976
    s_cmp_lg_u32 s54, 0
    s_cbranch_scc1 KG_nn
    v_readfirstlane_b32 s43, v13
    s_cmp_lg_u32 s43, 0
    s_cbranch_scc1 KG_godG
    s_mov_b32 s3, 0
KG_goG:
    buffer_load_dword v13, off, s[68:71], 0 sc1
    s_waitcnt vmcnt(0)
    v_readfirstlane_b32 s43, v13
    s_cmp_lg_u32 s43, 0
    s_cbranch_scc1 KG_godG
    s_add_u32 s3, s3, 1
    s_cmp_gt_u32 s3, 30000
    s_cbranch_scc1 K2_done0
    s_sleep 1
    s_branch KG_goG
KG_godG:
    ds_write_b32 v7, v13
KG_nn:
    v_mov_b32 v5, v0
    v_mov_b32 v0, 0x0d800000
    v_mov_b32 v1, 0x0d800000
    v_mov_b32 v2, 0x0d800000
    v_mov_b32 v3, 0x0d800000
    s_nop 1
    s_waitcnt lgkmcnt(0)
    v_mfma_f32_16x16x32_bf16 v[48:51], v[64:67], v[32:35], 0
    v_mfma_f32_16x16x32_bf16 v[52:55], v[16:19], v[32:35], v[0:3]
    v_mfma_f32_16x16x32_bf16 v[48:51], v[68:71], v[36:39], v[48:51]
    v_mfma_f32_16x16x32_bf16 v[52:55], v[20:23], v[36:39], v[52:55]
    v_mfma_f32_16x16x32_bf16 v[48:51], v[72:75], v[40:43], v[48:51]
    v_mfma_f32_16x16x32_bf16 v[52:55], v[24:27], v[40:43], v[52:55]
    v_mfma_f32_16x16x32_bf16 v[48:51], v[76:79], v[44:47], v[48:51]
    v_mfma_f32_16x16x32_bf16 v[52:55], v[28:31], v[44:47], v[52:55]
    s_nop 3
    ds_read_b128 v[32:35], v9 offset:37120
    ds_read_b128 v[36:39], v9 offset:37184
    ds_read_b128 v[40:43], v9 offset:37248
    ds_read_b128 v[44:47], v9 offset:37312
    s_waitcnt lgkmcnt(0)
    v_mfma_f32_16x16x32_bf16 v[56:59], v[64:67], v[32:35], 0
    v_mfma_f32_16x16x32_bf16 v[60:63], v[16:19], v[32:35], v[0:3]
    v_mfma_f32_16x16x32_bf16 v[56:59], v[68:71], v[36:39], v[56:59]
    v_mfma_f32_16x16x32_bf16 v[60:63], v[20:23], v[36:39], v[60:63]
    v_mfma_f32_16x16x32_bf16 v[56:59], v[72:75], v[40:43], v[56:59]
    v_mfma_f32_16x16x32_bf16 v[60:63], v[24:27], v[40:43], v[60:63]
    v_mfma_f32_16x16x32_bf16 v[56:59], v[76:79], v[44:47], v[56:59]
    v_mfma_f32_16x16x32_bf16 v[60:63], v[28:31], v[44:47], v[60:63]
    s_nop 3
    ds_read_b128 v[32:35], v9 offset:41472
    ds_read_b128 v[36:39], v9 offset:41536
    ds_read_b128 v[40:43], v9 offset:41600
    ds_read_b128 v[44:47], v9 offset:41664
    v_pk_mul_f32 v[48:49], v[48:49], s[62:63]
    v_pk_mul_f32 v[50:51], v[50:51], s[62:63]
    v_cvt_pk_bf16_f32 v48, v48, v49
    v_cvt_pk_bf16_f32 v49, v50, v51
    v_xor_b32 v50, s59, v48
    v_xor_b32 v51, s59, v49
    v_sub_u32_sdwa v52, v52, sext(v50) dst_sel:DWORD dst_unused:UNUSED_PAD src0_sel:DWORD src1_sel:WORD_0
    v_sub_u32_sdwa v53, v53, sext(v50) dst_sel:DWORD dst_unused:UNUSED_PAD src0_sel:DWORD src1_sel:WORD_1
    v_sub_u32_sdwa v54, v54, sext(v51) dst_sel:DWORD dst_unused:UNUSED_PAD src0_sel:DWORD src1_sel:WORD_0
    v_sub_u32_sdwa v55, v55, sext(v51) dst_sel:DWORD dst_unused:UNUSED_PAD src0_sel:DWORD src1_sel:WORD_1
    v_perm_b32 v52, v52, v48, s60
    v_perm_b32 v53, v53, v48, s61
    v_perm_b32 v54, v54, v49, s60
    v_perm_b32 v55, v55, v49, s61
    ds_write_b128 v6, v[52:55] offset:13056
    s_waitcnt lgkmcnt(0)
    s_barrier
    ds_read_b32 v11, v7
    v_mfma_f32_16x16x32_bf16 v[48:51], v[64:67], v[32:35], 0
    v_mfma_f32_16x16x32_bf16 v[52:55], v[16:19], v[32:35], v[0:3]
    v_mfma_f32_16x16x32_bf16 v[48:51], v[68:71], v[36:39], v[48:51]
    v_mfma_f32_16x16x32_bf16 v[52:55], v[20:23], v[36:39], v[52:55]
    v_mfma_f32_16x16x32_bf16 v[48:51], v[72:75], v[40:43], v[48:51]
    v_mfma_f32_16x16x32_bf16 v[52:55], v[24:27], v[40:43], v[52:55]
    v_mfma_f32_16x16x32_bf16 v[48:51], v[76:79], v[44:47], v[48:51]
    v_mfma_f32_16x16x32_bf16 v[52:55], v[28:31], v[44:47], v[52:55]
    ds_read_b128 v[12:15], v4 offset:13056
    ds_read_b128 v[32:35], v9 offset:45824
    ds_read_b128 v[36:39], v9 offset:45888
    ds_read_b128 v[40:43], v9 offset:45952
    ds_read_b128 v[44:47], v9 offset:46016
    v_pk_mul_f32 v[56:57], v[56:57], s[62:63]
    v_pk_mul_f32 v[58:59], v[58:59], s[62:63]
    v_cvt_pk_bf16_f32 v56, v56, v57
    v_cvt_pk_bf16_f32 v57, v58, v59
    v_xor_b32 v58, s59, v56
    v_xor_b32 v59, s59, v57
    v_sub_u32_sdwa v60, v60, sext(v58) dst_sel:DWORD dst_unused:UNUSED_PAD src0_sel:DWORD src1_sel:WORD_0
    v_sub_u32_sdwa v61, v61, sext(v58) dst_sel:DWORD dst_unused:UNUSED_PAD src0_sel:DWORD src1_sel:WORD_1
    v_sub_u32_sdwa v62, v62, sext(v59) dst_sel:DWORD dst_unused:UNUSED_PAD src0_sel:DWORD src1_sel:WORD_0
    v_sub_u32_sdwa v63, v63, sext(v59) dst_sel:DWORD dst_unused:UNUSED_PAD src0_sel:DWORD src1_sel:WORD_1
    v_perm_b32 v60, v60, v56, s60
    v_perm_b32 v61, v61, v56, s61
    v_perm_b32 v62, v62, v57, s60
    v_perm_b32 v63, v63, v57, s61
    ds_write_b128 v6, v[60:63] offset:21504
    s_waitcnt lgkmcnt(5)
    v_readfirstlane_b32 s43, v11
    s_lshr_b32 s76, s43, 10
    s_mul_i32 s76, s76, 0x9e3779b1
    s_lshr_b32 vcc_lo, s76, 15
    s_xor_b32 s76, s76, vcc_lo
    s_mul_i32 s76, s76, 0x85ebca6b
    s_and_b32 s76, s76, 0xf0000000
    s_lshr_b32 s76, s76, 4
    s_add_u32 s44, s44, s76
    s_addc_u32 s45, s45, 0
    s_add_u32 s64, s64, s76
    s_addc_u32 s65, s65, 0
    buffer_store_dwordx4 v[12:15], v10, s[44:47], s53 offen sc1
    s_add_u32 s53, s53, 8192
    s_waitcnt lgkmcnt(0)
    s_barrier
    v_mfma_f32_16x16x32_bf16 v[56:59], v[64:67], v[32:35], 0
    v_mfma_f32_16x16x32_bf16 v[60:63], v[16:19], v[32:35], v[0:3]
    v_mfma_f32_16x16x32_bf16 v[56:59], v[68:71], v[36:39], v[56:59]
    v_mfma_f32_16x16x32_bf16 v[60:63], v[20:23], v[36:39], v[60:63]
    v_mfma_f32_16x16x32_bf16 v[56:59], v[72:75], v[40:43], v[56:59]
    v_mfma_f32_16x16x32_bf16 v[60:63], v[24:27], v[40:43], v[60:63]
    v_mfma_f32_16x16x32_bf16 v[56:59], v[76:79], v[44:47], v[56:59]
    v_mfma_f32_16x16x32_bf16 v[60:63], v[28:31], v[44:47], v[60:63]
    ds_read_b128 v[12:15], v4 offset:21504
    ds_read_b128 v[32:35], v9 offset:0
    ds_read_b128 v[36:39], v9 offset:64
    ds_read_b128 v[40:43], v9 offset:128
    ds_read_b128 v[44:47], v9 offset:192
    v_pk_mul_f32 v[48:49], v[48:49], s[62:63]
    v_pk_mul_f32 v[50:51], v[50:51], s[62:63]
    v_cvt_pk_bf16_f32 v48, v48, v49
    v_cvt_pk_bf16_f32 v49, v50, v51
    v_xor_b32 v50, s59, v48
    v_xor_b32 v51, s59, v49
    v_sub_u32_sdwa v52, v52, sext(v50) dst_sel:DWORD dst_unused:UNUSED_PAD src0_sel:DWORD src1_sel:WORD_0
    v_sub_u32_sdwa v53, v53, sext(v50) dst_sel:DWORD dst_unused:UNUSED_PAD src0_sel:DWORD src1_sel:WORD_1
    v_sub_u32_sdwa v54, v54, sext(v51) dst_sel:DWORD dst_unused:UNUSED_PAD src0_sel:DWORD src1_sel:WORD_0
    v_sub_u32_sdwa v55, v55, sext(v51) dst_sel:DWORD dst_unused:UNUSED_PAD src0_sel:DWORD src1_sel:WORD_1
    v_perm_b32 v52, v52, v48, s60
    v_perm_b32 v53, v53, v48, s61
    v_perm_b32 v54, v54, v49, s60
    v_perm_b32 v55, v55, v49, s61
    ds_write_b128 v6, v[52:55] offset:13056
    s_waitcnt lgkmcnt(5)
    buffer_store_dwordx4 v[12:15], v10, s[44:47], s53 offen sc1
    s_add_u32 s53, s53, 8192
    s_waitcnt lgkmcnt(0)
    s_barrier
    v_mfma_f32_16x16x32_bf16 v[48:51], v[64:67], v[32:35], 0
    v_mfma_f32_16x16x32_bf16 v[52:55], v[16:19], v[32:35], v[0:3]
    v_mfma_f32_16x16x32_bf16 v[48:51], v[68:71], v[36:39], v[48:51]
    v_mfma_f32_16x16x32_bf16 v[52:55], v[20:23], v[36:39], v[52:55]
    v_mfma_f32_16x16x32_bf16 v[48:51], v[72:75], v[40:43], v[48:51]
    v_mfma_f32_16x16x32_bf16 v[52:55], v[24:27], v[40:43], v[52:55]
    v_mfma_f32_16x16x32_bf16 v[48:51], v[76:79], v[44:47], v[48:51]
    v_mfma_f32_16x16x32_bf16 v[52:55], v[28:31], v[44:47], v[52:55]
    ds_read_b128 v[12:15], v4 offset:13056
    ds_read_b128 v[32:35], v9 offset:4352
    ds_read_b128 v[36:39], v9 offset:4416
    ds_read_b128 v[40:43], v9 offset:4480
    ds_read_b128 v[44:47], v9 offset:4544
    v_pk_mul_f32 v[56:57], v[56:57], s[62:63]
    v_pk_mul_f32 v[58:59], v[58:59], s[62:63]
    v_cvt_pk_bf16_f32 v56, v56, v57
    v_cvt_pk_bf16_f32 v57, v58, v59
    v_xor_b32 v58, s59, v56
    v_xor_b32 v59, s59, v57
    v_sub_u32_sdwa v60, v60, sext(v58) dst_sel:DWORD dst_unused:UNUSED_PAD src0_sel:DWORD src1_sel:WORD_0
    v_sub_u32_sdwa v61, v61, sext(v58) dst_sel:DWORD dst_unused:UNUSED_PAD src0_sel:DWORD src1_sel:WORD_1
    v_sub_u32_sdwa v62, v62, sext(v59) dst_sel:DWORD dst_unused:UNUSED_PAD src0_sel:DWORD src1_sel:WORD_0
    v_sub_u32_sdwa v63, v63, sext(v59) dst_sel:DWORD dst_unused:UNUSED_PAD src0_sel:DWORD src1_sel:WORD_1
    v_perm_b32 v60, v60, v56, s60
    v_perm_b32 v61, v61, v56, s61
    v_perm_b32 v62, v62, v57, s60
    v_perm_b32 v63, v63, v57, s61
    ds_write_b128 v6, v[60:63] offset:21504
    s_waitcnt lgkmcnt(5)
    buffer_store_dwordx4 v[12:15], v10, s[44:47], s53 offen sc1
    s_add_u32 s53, s53, 8192
    s_waitcnt lgkmcnt(0)
    s_barrier
    v_mfma_f32_16x16x32_bf16 v[56:59], v[64:67], v[32:35], 0
    v_mfma_f32_16x16x32_bf16 v[60:63], v[16:19], v[32:35], v[0:3]
    v_mfma_f32_16x16x32_bf16 v[56:59], v[68:71], v[36:39], v[56:59]
    v_mfma_f32_16x16x32_bf16 v[60:63], v[20:23], v[36:39], v[60:63]
    v_mfma_f32_16x16x32_bf16 v[56:59], v[72:75], v[40:43], v[56:59]
    v_mfma_f32_16x16x32_bf16 v[60:63], v[24:27], v[40:43], v[60:63]
    v_mfma_f32_16x16x32_bf16 v[56:59], v[76:79], v[44:47], v[56:59]
    v_mfma_f32_16x16x32_bf16 v[60:63], v[28:31], v[44:47], v[60:63]
    ds_read_b128 v[12:15], v4 offset:21504
    ds_read_b128 v[32:35], v9 offset:8704
    ds_read_b128 v[36:39], v9 offset:8768
    ds_read_b128 v[40:43], v9 offset:8832
    ds_read_b128 v[44:47], v9 offset:8896
    v_pk_mul_f32 v[48:49], v[48:49], s[62:63]
    v_pk_mul_f32 v[50:51], v[50:51], s[62:63]
    v_cvt_pk_bf16_f32 v48, v48, v49
    v_cvt_pk_bf16_f32 v49, v50, v51
    v_xor_b32 v50, s59, v48
    v_xor_b32 v51, s59, v49
    v_sub_u32_sdwa v52, v52, sext(v50) dst_sel:DWORD dst_unused:UNUSED_PAD src0_sel:DWORD src1_sel:WORD_0
    v_sub_u32_sdwa v53, v53, sext(v50) dst_sel:DWORD dst_unused:UNUSED_PAD src0_sel:DWORD src1_sel:WORD_1
    v_sub_u32_sdwa v54, v54, sext(v51) dst_sel:DWORD dst_unused:UNUSED_PAD src0_sel:DWORD src1_sel:WORD_0
    v_sub_u32_sdwa v55, v55, sext(v51) dst_sel:DWORD dst_unused:UNUSED_PAD src0_sel:DWORD src1_sel:WORD_1
    v_perm_b32 v52, v52, v48, s60
    v_perm_b32 v53, v53, v48, s61
    v_perm_b32 v54, v54, v49, s60
    v_perm_b32 v55, v55, v49, s61
    ds_write_b128 v6, v[52:55] offset:13056
    s_waitcnt lgkmcnt(5)
    buffer_store_dwordx4 v[12:15], v10, s[44:47], s53 offen sc1
    s_add_u32 s53, s53, 8192
    s_waitcnt lgkmcnt(0)
    s_barrier
    v_mfma_f32_16x16x32_bf16 v[48:51], v[64:67], v[32:35], 0
    v_mfma_f32_16x16x32_bf16 v[52:55], v[16:19], v[32:35], v[0:3]
    v_mfma_f32_16x16x32_bf16 v[48:51], v[68:71], v[36:39], v[48:51]
    v_mfma_f32_16x16x32_bf16 v[52:55], v[20:23], v[36:39], v[52:55]
    v_mfma_f32_16x16x32_bf16 v[48:51], v[72:75], v[40:43], v[48:51]
    v_mfma_f32_16x16x32_bf16 v[52:55], v[24:27], v[40:43], v[52:55]
    v_mfma_f32_16x16x32_bf16 v[48:51], v[76:79], v[44:47], v[48:51]
    v_mfma_f32_16x16x32_bf16 v[52:55], v[28:31], v[44:47], v[52:55]
    ds_read_b128 v[12:15], v4 offset:13056
    v_pk_mul_f32 v[56:57], v[56:57], s[62:63]
    v_pk_mul_f32 v[58:59], v[58:59], s[62:63]
    v_cvt_pk_bf16_f32 v56, v56, v57
    v_cvt_pk_bf16_f32 v57, v58, v59
    v_xor_b32 v58, s59, v56
    v_xor_b32 v59, s59, v57
    v_sub_u32_sdwa v60, v60, sext(v58) dst_sel:DWORD dst_unused:UNUSED_PAD src0_sel:DWORD src1_sel:WORD_0
    v_sub_u32_sdwa v61, v61, sext(v58) dst_sel:DWORD dst_unused:UNUSED_PAD src0_sel:DWORD src1_sel:WORD_1
    v_sub_u32_sdwa v62, v62, sext(v59) dst_sel:DWORD dst_unused:UNUSED_PAD src0_sel:DWORD src1_sel:WORD_0
    v_sub_u32_sdwa v63, v63, sext(v59) dst_sel:DWORD dst_unused:UNUSED_PAD src0_sel:DWORD src1_sel:WORD_1
    v_perm_b32 v60, v60, v56, s60
    v_perm_b32 v61, v61, v56, s61
    v_perm_b32 v62, v62, v57, s60
    v_perm_b32 v63, v63, v57, s61
    ds_write_b128 v6, v[60:63] offset:21504
    s_waitcnt lgkmcnt(1)
    buffer_store_dwordx4 v[12:15], v10, s[44:47], s53 offen sc1
    s_add_u32 s53, s53, 8192
    s_waitcnt lgkmcnt(0)
    s_barrier
    ds_read_b128 v[12:15], v4 offset:21504
    v_pk_mul_f32 v[48:49], v[48:49], s[62:63]
    v_pk_mul_f32 v[50:51], v[50:51], s[62:63]
    v_cvt_pk_bf16_f32 v48, v48, v49
    v_cvt_pk_bf16_f32 v49, v50, v51
    v_xor_b32 v50, s59, v48
    v_xor_b32 v51, s59, v49
    v_sub_u32_sdwa v52, v52, sext(v50) dst_sel:DWORD dst_unused:UNUSED_PAD src0_sel:DWORD src1_sel:WORD_0
    v_sub_u32_sdwa v53, v53, sext(v50) dst_sel:DWORD dst_unused:UNUSED_PAD src0_sel:DWORD src1_sel:WORD_1
    v_sub_u32_sdwa v54, v54, sext(v51) dst_sel:DWORD dst_unused:UNUSED_PAD src0_sel:DWORD src1_sel:WORD_0
    v_sub_u32_sdwa v55, v55, sext(v51) dst_sel:DWORD dst_unused:UNUSED_PAD src0_sel:DWORD src1_sel:WORD_1
    v_perm_b32 v52, v52, v48, s60
    v_perm_b32 v53, v53, v48, s61
    v_perm_b32 v54, v54, v49, s60
    v_perm_b32 v55, v55, v49, s61
    ds_write_b128 v6, v[52:55] offset:13056
    s_waitcnt lgkmcnt(1)
    buffer_store_dwordx4 v[12:15], v10, s[44:47], s53 offen sc1
    s_add_u32 s53, s53, 8192
    s_waitcnt lgkmcnt(0)
    s_barrier
    ds_read_b128 v[12:15], v4 offset:13056
    s_waitcnt lgkmcnt(0)
    buffer_store_dwordx4 v[12:15], v10, s[44:47], s53 offen sc1
    v_mov_b32 v1, 52976
    v_mov_b32 v0, v5
    s_cmp_lg_u32 s52, 127
    s_cbranch_scc1 KG_nd
    s_add_u32 s36, s26, 0x61c000
    s_addc_u32 s37, s27, 0
    s_mov_b32 s38, 0x4000
    s_mov_b32 s39, 0x00020000
    s_add_u32 s36, s36, s76
    s_addc_u32 s37, s37, 0
    v_mov_b32 v48, 0x4f00
    v_mov_b32 v49, 0x4f00
    v_mov_b32 v50, 0x4f00
    v_mov_b32 v51, 0x4f00
    buffer_store_dwordx4 v[48:51], v10, s[36:39], 0 offen sc1
    buffer_store_dwordx4 v[48:51], v10, s[36:39], s72 offen sc1
    s_nop 1
KG_nd:
    v_mov_b32 v2, v11
    s_waitcnt vmcnt(0) lgkmcnt(0)
    s_barrier
    s_cmp_lg_u32 s54, 0
    s_cbranch_scc1 KG_x
    v_lshlrev_b32 v8, 9, v8
    s_lshl_b32 s52, s52, 2
    buffer_store_dword v2, v8, s[64:67], s52 offen sc1
KG_x:
    s_branch K2_start
K2_start0:
    s_setprio 3
K2_start:
    s_load_dwordx2 s[4:5], s[0:1], 0
    s_load_dwordx8 s[64:71], s[0:1], 32
    s_load_dwordx4 s[8:11], s[0:1], 72
    s_load_dwordx2 s[6:7], s[0:1], 88
    s_and_b32 s46, s2, 1
    s_bfe_u32 s47, s2, 0x20001
    s_bfe_u32 s48, s2, 0x40003
    s_lshr_b32 s49, s2, 8
    s_lshl4_add_u32 s48, s49, s48
    s_bitcmp1_b32 s2, 7
    s_cselect_b32 s49, 47, 48
    s_cselect_b32 s51, 32, 34
    s_cselect_b32 s50, 6528, 0
    s_cselect_b32 s3, 204, 12
    s_mul_i32 s47, s47, s49
    s_add_u32 s47, s47, s48
    s_mul_i32 s49, s47, s51
    s_add_u32 s50, s50, s49
    s_add_u32 s47, s47, s3
    v_and_b32 v1, 63, v0
    v_lshrrev_b32 v2, 6, v0
    v_and_b32 v3, 15, v0
    v_bfe_u32 v4, v0, 4, 2
    v_readfirstlane_b32 s48, v2
    v_lshrrev_b32 v6, 2, v0
    v_and_b32 v5, 15, v6
    v_lshrrev_b32 v7, 4, v6
    v_lshl_add_u32 v7, v5, 3, v7
    v_lshlrev_b32 v7, 12, v7
    v_lshlrev_b32 v10, 4, v0
    v_lshrrev_b32 v11, 3, v0
    v_and_b32 v9, 7, v0
    v_lshlrev_b32 v9, 4, v9
    v_lshl_add_u32 v11, v11, 8, v9
    s_lshl_b32 s62, s46, 7
    s_add_u32 s63, s62, 16384
    s_lshl_b32 s49, s47, 3
    v_cmp_gt_u32 s[44:45], 32, v0
    s_lshl_b32 s59, s50, 8
    s_add_u32 s60, s59, 8192
    s_and_b32 s56, s48, 1
    s_lshr_b32 s57, s48, 1
    v_mov_b32 v32, 52976
    ds_read_b32 v33, v32
    s_waitcnt lgkmcnt(0)
    s_mov_b32 s32, s10
    s_mov_b32 s33, s11
    s_mov_b32 s34, 0x100
    s_mov_b32 s35, 0x00020000
    s_sub_u32 s12, s2, 256
    s_or_b32 s13, s12, s48
    s_cmp_ge_u32 s12, 8
    s_cselect_b32 s13, 1, s48
    s_cmp_lg_u32 s13, 0
    s_cbranch_scc1 KP_n0
    s_memrealtime s[12:13]
    s_waitcnt lgkmcnt(0)
    s_or_b32 s12, s12, 1
    v_mov_b32 v34, s12
    v_mov_b32 v35, 0
    s_mov_b64 exec, 1
    buffer_atomic_cmpswap v[34:35], off, s[32:35], 0 sc1
    s_mov_b64 exec, -1
KP_n0:
    s_mov_b32 s10, s6
    s_mov_b32 s11, s7
    v_readfirstlane_b32 s43, v33
    s_cmp_ge_u32 s2, 256
    s_cselect_b32 s43, 0, s43
    s_lshr_b32 s12, s43, 10
    s_mul_i32 s12, s12, 0x9e3779b1
    s_lshr_b32 vcc_lo, s12, 15
    s_xor_b32 s12, s12, vcc_lo
    s_mul_i32 s12, s12, 0x85ebca6b
    s_and_b32 s12, s12, 0xf0000000
    s_lshr_b32 s12, s12, 4
    s_add_u32 s10, s10, s12
    s_addc_u32 s11, s11, 0
    s_add_u32 s12, s10, 0x800000
    s_addc_u32 s13, s11, 0
    s_mov_b32 s14, 0x80000
    s_mov_b32 s15, 0x00020000
    v_readfirstlane_b32 s43, v33
    s_cmp_ge_u32 s2, 256
    s_cselect_b32 s43, 0, s43
    s_cbranch_scc1 K2_nt0
    v_mov_b32 v63, 0
    s_cmp_lt_u32 s2, 128
    s_cbranch_scc1 K2_nt0
    buffer_load_dwordx2 v[62:63], v7, s[12:15], s49 offen sc1
K2_nt0:
    s_mov_b32 s28, s64
    s_mov_b32 s29, s65
    s_mov_b32 s30, 0x8000
    s_mov_b32 s31, 0x00020000
    s_mov_b32 s72, s70
    s_mov_b32 s73, s71
    s_mov_b32 s74, 0x8000
    s_mov_b32 s75, 0x00020000
    s_mov_b32 s36, s4
    s_mov_b32 s37, s5
    s_mov_b32 s38, 0x30d400
    s_mov_b32 s39, 0x00020000
    buffer_load_dwordx4 v[16:19], v11, s[28:31], s62 offen
    buffer_load_dwordx4 v[20:23], v11, s[28:31], s63 offen
    buffer_load_dwordx4 v[24:27], v11, s[72:75], s62 offen
    buffer_load_dwordx4 v[28:31], v11, s[72:75], s63 offen
    buffer_load_dwordx4 v[48:51], v10, s[36:39], s59 offen
    s_cmp_lg_u32 s48, 0
    s_cbranch_scc1 K2_nx2
    s_mov_b64 exec, s[44:45]
    buffer_load_dwordx4 v[52:55], v10, s[36:39], s60 offen
    s_mov_b64 exec, -1
K2_nx2:
    s_cmp_lg_u32 s48, 7
    s_cbranch_scc1 K2_nwc
    s_mov_b32 s72, s68
    s_mov_b32 s73, s69
    s_mov_b32 s74, 0x400
    s_mov_b32 s75, 0x00020000
    v_lshlrev_b32 v9, 3, v3
    v_lshl_add_u32 v9, v4, 1, v9
    buffer_load_ushort v56, v9, s[72:75], s62 offen offset:0
    buffer_load_ushort v57, v9, s[72:75], s62 offen offset:256
    buffer_load_ushort v58, v9, s[72:75], s62 offen offset:512
    buffer_load_ushort v59, v9, s[72:75], s62 offen offset:768
K2_nwc:
    s_add_u32 s20, s10, 0x740000
    s_addc_u32 s21, s11, 0
    s_mov_b32 s22, 0x4000
    s_mov_b32 s23, 0x00020000
    v_mov_b32 v12, 0
    v_mov_b32 v13, 0
    v_mov_b32 v14, 0
    v_mov_b32 v15, 0
    v_cmp_gt_u32 vcc, 32, v0
    s_and_saveexec_b64 s[44:45], vcc
    ds_write_b128 v10, v[12:15] offset:0
    s_mov_b64 exec, s[44:45]
    s_add_u32 s16, s10, 0x900000
    s_addc_u32 s17, s11, 0
    s_mov_b32 s18, 0x494000
    s_mov_b32 s19, 0x00020000
    v_and_b32 v2, 3, v0
    v_and_b32 v5, 15, v6
    v_lshrrev_b32 v6, 4, v6
    v_lshl_add_u32 v6, v5, 3, v6
    v_mul_u32_u24 v6, 37504, v6
    s_mov_b32 s24, s10
    s_or_b32 s25, s11, 0x2000000
    s_movk_i32 s26, 12544
    s_mov_b32 s27, 0x00020000
    s_mov_b32 s52, s8
    s_mov_b32 s53, s9
    s_mov_b32 s54, 0x30d400
    s_mov_b32 s55, 0x00020000
    s_mov_b32 s40, 0x22221111
    s_mov_b32 s41, 0x88884444
    s_movk_i32 s42, 512
    s_lshl_b32 s79, s50, 8
    s_add_u32 s79, s79, s62
    s_lshl_b32 s62, s46, 8
    s_sub_u32 s78, 23760, s62
    v_lshl_add_u32 v75, v3, 4, s62
    v_lshl_add_u32 v77, v3, 4, s62
    v_lshrrev_b32 v11, 2, v3
    v_and_b32 v9, 3, v3
    v_mov_b32 v68, 0x3f80
    v_cmp_eq_u32 s[44:45], v4, v11
    v_cmp_eq_u32 vcc, 0, v9
    s_and_b64 s[62:63], s[44:45], vcc
    s_nop 0
    v_cndmask_b32 v70, 0, v68, s[62:63]
    v_cmp_eq_u32 vcc, 1, v9
    s_and_b64 s[62:63], s[44:45], vcc
    s_nop 0
    v_cndmask_b32 v71, 0, v68, s[62:63]
    v_cmp_eq_u32 vcc, 2, v9
    s_and_b64 s[62:63], s[44:45], vcc
    s_nop 0
    v_cndmask_b32 v72, 0, v68, s[62:63]
    v_cmp_eq_u32 vcc, 3, v9
    s_and_b64 s[62:63], s[44:45], vcc
    s_nop 0
    v_cndmask_b32 v73, 0, v68, s[62:63]
    v_lshl_add_u32 v60, v4, 3, v11
    v_lshlrev_b32 v60, 7, v60
    v_lshl_add_u32 v60, v9, 3, v60
    s_lshl_b32 s62, s56, 14
    v_add_u32 v60, s62, v60
    v_lshrrev_b32 v9, 1, v11
    v_and_b32 v11, 1, v4
    v_lshl_or_b32 v9, v11, 1, v9
    v_xor_b32 v9, s57, v9
    v_lshl_add_u32 v60, v9, 5, v60
    v_bfe_u32 v9, v0, 6, 1
    v_lshl_or_b32 v9, v9, 1, v11
    v_lshlrev_b32 v9, 5, v9
    v_xor_b32 v64, v10, v9
    s_sub_u32 s62, 12500, s50
    s_min_u32 s51, s51, s62
    s_mov_b32 s62, 0xbfb8aa3b
    s_mov_b32 s61, s56
    s_sub_u32 s65, 2, s56
    s_add_u32 s64, s65, 4
    s_lshl_b32 s64, s57, s64
    s_cmp_eq_u32 s56, 0
    s_mov_b32 s63, 32464
    s_cselect_b32 s63, 23760, s63
    s_add_u32 s63, s63, s64
    s_mov_b32 s58, 0x00ff00ff
    s_lshl_b32 s64, s46, 3
    s_lshl_b32 s58, s58, s64
    s_mov_b32 s59, s58
    s_mov_b32 s56, 0x21800000
    s_mov_b32 s57, 0x21800000
    v_mov_b32 v68, 0xc2700000
    v_and_b32 v11, 0x1f0, v0
    v_add_u32 v11, v11, v10
    v_cmp_gt_u32 s[76:77], 32, v0
    v_and_b32 v61, 0xffffff7f, v10
    v_lshlrev_b32 v8, 10, v4
    v_lshl_add_u32 v8, v3, s65, v8
    v_add_u32 v8, s63, v8
    v_mul_u32_u24 v9, 272, v3
    v_lshl_add_u32 v9, v4, 4, v9
    v_mov_b32 v65, 52976
    s_or_b32 s64, s48, s43
    s_cmp_lg_u32 s64, 0
    s_cbranch_scc1 K2_ngo
    s_mov_b32 s3, 0
KG_goC:
    buffer_load_dword v66, off, s[32:35], 0 sc1
    s_waitcnt vmcnt(0)
    v_readfirstlane_b32 s43, v66
    s_cmp_lg_u32 s43, 0
    s_cbranch_scc1 KG_godC
    s_add_u32 s3, s3, 1
    s_cmp_gt_u32 s3, 30000
    s_cbranch_scc1 K2_done0
    s_sleep 4
    s_branch KG_goC
KG_godC:
    ds_write_b32 v65, v66
    s_mov_b32 s43, 0
K2_ngo:
    s_waitcnt vmcnt(0)
    ds_write_b128 v64, v[16:19] offset:512
    ds_write_b128 v64, v[20:23] offset:8704
    ds_write_b128 v64, v[24:27] offset:16896
    ds_write_b128 v64, v[28:31] offset:25088
    ds_write_b128 v11, v[48:51] offset:41168
    s_cmp_lg_u32 s48, 0
    s_cbranch_scc1 K2_nx3
    s_mov_b64 exec, s[76:77]
    ds_write_b128 v11, v[52:55] offset:49872
    s_mov_b64 exec, -1
K2_nx3:
    s_cmp_lg_u32 s48, 7
    s_cbranch_scc1 K2_nwc3
    v_lshlrev_b32 v56, 16, v56
    v_mul_f32 v56, s62, v56
    v_lshlrev_b32 v57, 16, v57
    v_mul_f32 v57, s62, v57
    v_lshlrev_b32 v58, 16, v58
    v_mul_f32 v58, s62, v58
    v_lshlrev_b32 v59, 16, v59
    v_mul_f32 v59, s62, v59
    v_cvt_pk_bf16_f32 v56, v56, v57
    v_cvt_pk_bf16_f32 v57, v58, v59
    v_lshlrev_b32 v11, 3, v1
    ds_write_b64 v11, v[56:57] offset:50416
K2_nwc3:
    s_waitcnt lgkmcnt(0)
    s_barrier
    ds_read_b64_tr_b16 v[16:17], v60 offset:512
    ds_read_b64_tr_b16 v[18:19], v60 offset:1024
    ds_read_b64_tr_b16 v[20:21], v60 offset:4608
    ds_read_b64_tr_b16 v[22:23], v60 offset:5120
    ds_read_b64_tr_b16 v[24:25], v60 offset:8704
    ds_read_b64_tr_b16 v[26:27], v60 offset:9216
    ds_read_b64_tr_b16 v[28:29], v60 offset:12800
    ds_read_b64_tr_b16 v[30:31], v60 offset:13312
    ds_read_b32 v66, v65
    ds_read_b128 v[32:35], v9 offset:41168
    ds_read_b128 v[36:39], v9 offset:41232
    ds_read_b128 v[40:43], v9 offset:41296
    ds_read_b128 v[44:47], v9 offset:41360
    s_waitcnt lgkmcnt(4)
    s_barrier
    s_mov_b64 exec, s[58:59]
    ds_write_b128 v61, v[48:51] offset:32592
    s_cmp_lg_u32 s48, 0
    s_cbranch_scc1 K2_nx4
    s_and_b64 exec, exec, s[76:77]
    ds_write_b128 v61, v[52:55] offset:40784
K2_nx4:
    s_mov_b64 exec, -1
    s_cmp_eq_u32 s43, 0
    s_cbranch_scc1 K2_late
    v_cmp_ne_u32 vcc, s43, v63
    s_cbranch_vccnz K2_late
    v_lshrrev_b32 v11, 16, v62
    v_and_b32 v5, 0xffff, v62
    v_add_u32 v7, v11, v2
    v_sub_u32 v5, v5, v2
    v_mad_u32_u24 v7, v7, 12, v6
    v_cmp_lt_i32 s[74:75], 16, v5
    v_cmp_lt_i32 s[72:73], 12, v5
    v_cmp_lt_i32 s[66:67], 0, v5
    v_cmp_lt_i32 s[68:69], 4, v5
    v_cmp_lt_i32 s[70:71], 8, v5
    s_mov_b64 exec, s[74:75]
    s_cbranch_execz K2_nr4e
    buffer_load_dwordx3 v[64:66], v7, s[16:19], 0 offen offset:192 sc1
K2_nr4e:
    s_mov_b64 exec, s[72:73]
    s_cbranch_execz K2_nr3e
    buffer_load_dwordx3 v[60:62], v7, s[16:19], 0 offen offset:144 sc1
K2_nr3e:
    s_mov_b64 exec, s[66:67]
    buffer_load_dwordx3 v[48:50], v7, s[16:19], 0 offen offset:0 sc1
    s_mov_b64 exec, s[68:69]
    buffer_load_dwordx3 v[52:54], v7, s[16:19], 0 offen offset:48 sc1
    s_mov_b64 exec, s[70:71]
    buffer_load_dwordx3 v[56:58], v7, s[16:19], 0 offen offset:96 sc1
    s_mov_b64 exec, -1
    s_waitcnt lgkmcnt(0)
    v_mfma_f32_16x16x32_bf16 v[12:15], v[32:35], v[16:19], 0
    v_mfma_f32_16x16x32_bf16 v[12:15], v[36:39], v[20:23], v[12:15]
    v_mfma_f32_16x16x32_bf16 v[12:15], v[40:43], v[24:27], v[12:15]
    v_mfma_f32_16x16x32_bf16 v[12:15], v[44:47], v[28:31], v[12:15]
    ds_read_b128 v[32:35], v9 offset:45520
    ds_read_b128 v[36:39], v9 offset:45584
    ds_read_b128 v[40:43], v9 offset:45648
    ds_read_b128 v[44:47], v9 offset:45712
    s_nop 3
    s_cmp_lg_u32 s61, 0
    s_cbranch_scc1 K2_tu0e
    v_fma_f32 v12, v12, s62, v68
    v_fma_f32 v13, v13, s62, v68
    v_fma_f32 v14, v14, s62, v68
    v_fma_f32 v15, v15, s62, v68
    ds_write_b32 v8, v12 offset:0
    ds_write_b32 v8, v13 offset:256
    ds_write_b32 v8, v14 offset:512
    ds_write_b32 v8, v15 offset:768
    s_branch K2_te0e
K2_tu0e:
    v_cvt_pk_bf16_f32 v12, v12, v13
    v_cvt_pk_bf16_f32 v14, v14, v15
    ds_write_b16 v8, v12 offset:0
    ds_write_b16_d16_hi v8, v12 offset:256
    ds_write_b16 v8, v14 offset:512
    ds_write_b16_d16_hi v8, v14 offset:768
K2_te0e:
    s_waitcnt lgkmcnt(4)
    v_mfma_f32_16x16x32_bf16 v[12:15], v[32:35], v[16:19], 0
    v_mfma_f32_16x16x32_bf16 v[12:15], v[36:39], v[20:23], v[12:15]
    v_mfma_f32_16x16x32_bf16 v[12:15], v[40:43], v[24:27], v[12:15]
    v_mfma_f32_16x16x32_bf16 v[12:15], v[44:47], v[28:31], v[12:15]
    ds_read_b128 v[32:35], v9 offset:49872
    ds_read_b128 v[36:39], v9 offset:49936
    ds_read_b128 v[40:43], v9 offset:50000
    ds_read_b128 v[44:47], v9 offset:50064
    s_nop 3
    s_cmp_lg_u32 s61, 0
    s_cbranch_scc1 K2_tu1e
    v_fma_f32 v12, v12, s62, v68
    v_fma_f32 v13, v13, s62, v68
    v_fma_f32 v14, v14, s62, v68
    v_fma_f32 v15, v15, s62, v68
    ds_write_b32 v8, v12 offset:4096
    ds_write_b32 v8, v13 offset:4352
    ds_write_b32 v8, v14 offset:4608
    ds_write_b32 v8, v15 offset:4864
    s_branch K2_te1e
K2_tu1e:
    v_cvt_pk_bf16_f32 v12, v12, v13
    v_cvt_pk_bf16_f32 v14, v14, v15
    ds_write_b16 v8, v12 offset:4096
    ds_write_b16_d16_hi v8, v12 offset:4352
    ds_write_b16 v8, v14 offset:4608
    ds_write_b16_d16_hi v8, v14 offset:4864
K2_te1e:
K2_e2:
    s_waitcnt lgkmcnt(4)
    v_mfma_f32_16x16x32_bf16 v[12:15], v[32:35], v[16:19], 0
    v_mfma_f32_16x16x32_bf16 v[12:15], v[36:39], v[20:23], v[12:15]
    v_mfma_f32_16x16x32_bf16 v[12:15], v[40:43], v[24:27], v[12:15]
    v_mfma_f32_16x16x32_bf16 v[12:15], v[44:47], v[28:31], v[12:15]
    s_nop 7
    s_mov_b64 exec, 0xffff
    s_cmp_lg_u32 s61, 0
    s_cbranch_scc1 K2_tu2e
    v_fma_f32 v12, v12, s62, v68
    v_fma_f32 v13, v13, s62, v68
    ds_write_b32 v8, v12 offset:8192
    ds_write_b32 v8, v13 offset:8448
    s_branch K2_te2e
K2_tu2e:
    v_cvt_pk_bf16_f32 v12, v12, v13
    ds_write_b16 v8, v12 offset:8192
    ds_write_b16_d16_hi v8, v12 offset:8448
K2_te2e:
    s_mov_b64 exec, -1
    v_lshlrev_b32 v24, 3, v1
    ds_read_b64 v[68:69], v24 offset:50416
    v_mov_b32 v40, 0
    v_mov_b32 v41, 0
    v_mov_b32 v42, 0
    v_mov_b32 v43, 0
    v_mov_b32 v32, 0
    v_mov_b32 v36, 0x538637bd
    v_mov_b32 v33, 0
    v_mov_b32 v37, 0x538637bd
    v_mov_b32 v34, 0
    v_mov_b32 v38, 0x538637bd
    v_mov_b32 v35, 0
    v_mov_b32 v39, 0x538637bd
    v_mov_b32 v30, 8
    v_and_b32 v14, 31, v0
    v_lshrrev_b32 v15, 5, v0
    v_lshlrev_b32 v12, 2, v14
    v_lshlrev_b32 v13, 3, v15
    v_lshlrev_b32 v15, 1, v15
    v_sub_u32 v14, v14, v15
    v_add_u32 v15, -1, v14
    s_lshl_b32 s58, s48, 2
    s_mov_b32 s65, 0x45673210
    s_cmp_gt_u32 s51, 32
    s_cselect_b32 s65, 0x67453210, s65
    s_lshr_b32 s58, s65, s58
    s_and_b32 s58, s58, 15
    s_lshl_b32 s58, s58, 2
    v_add_lshl_u32 v17, s58, v4, 2
    v_lshrrev_b32 v18, 2, v3
    v_add_lshl_u32 v18, s58, v18, 2
    s_lshl_b32 s65, s48, 8
    v_lshl_add_u32 v19, v1, 2, s65
    v_and_b32 v16, 31, v1
    v_add_u32 v16, 12512, v16
    v_mov_b32 v20, 512
    v_mov_b32 v21, 5200
    v_add_u32 v31, s78, v75
    s_mov_b32 s77, s79
    s_mov_b32 s28, s10
    s_mov_b32 s29, s11
    s_mov_b32 s30, 0x620000
    s_mov_b32 s31, 0x00020000
    s_and_b32 s59, s2, 31
    s_lshl_b32 s59, s59, 9
    s_movk_i32 s63, 136
    s_movk_i32 s62, 544
    s_sub_u32 s76, 39, s48
    s_cmp_lt_u32 s76, s51
    s_cselect_b32 s76, 2, 0
    s_waitcnt lgkmcnt(0)
    s_branch K2_rk
K2_late:
    s_waitcnt lgkmcnt(0)
    s_cmp_eq_u32 s43, 0
    v_readfirstlane_b32 s43, v66
    s_cselect_b32 s3, s43, 0
    s_lshr_b32 s3, s3, 10
    s_mul_i32 s3, s3, 0x9e3779b1
    s_lshr_b32 vcc_lo, s3, 15
    s_xor_b32 s3, s3, vcc_lo
    s_mul_i32 s3, s3, 0x85ebca6b
    s_and_b32 s3, s3, 0xf0000000
    s_lshr_b32 s3, s3, 4
    s_add_u32 s10, s10, s3
    s_addc_u32 s11, s11, 0
    s_add_u32 s12, s12, s3
    s_addc_u32 s13, s13, 0
    s_add_u32 s16, s16, s3
    s_addc_u32 s17, s17, 0
    s_add_u32 s20, s20, s3
    s_addc_u32 s21, s21, 0
    s_add_u32 s24, s24, s3
    s_addc_u32 s25, s25, 0
    v_mfma_f32_16x16x32_bf16 v[12:15], v[32:35], v[16:19], 0
    v_mfma_f32_16x16x32_bf16 v[12:15], v[36:39], v[20:23], v[12:15]
    v_mfma_f32_16x16x32_bf16 v[12:15], v[40:43], v[24:27], v[12:15]
    v_mfma_f32_16x16x32_bf16 v[12:15], v[44:47], v[28:31], v[12:15]
    ds_read_b128 v[32:35], v9 offset:45520
    ds_read_b128 v[36:39], v9 offset:45584
    ds_read_b128 v[40:43], v9 offset:45648
    ds_read_b128 v[44:47], v9 offset:45712
    s_nop 3
    s_cmp_lg_u32 s61, 0
    s_cbranch_scc1 K2_tu0l
    v_fma_f32 v12, v12, s62, v68
    v_fma_f32 v13, v13, s62, v68
    v_fma_f32 v14, v14, s62, v68
    v_fma_f32 v15, v15, s62, v68
    ds_write_b32 v8, v12 offset:0
    ds_write_b32 v8, v13 offset:256
    ds_write_b32 v8, v14 offset:512
    ds_write_b32 v8, v15 offset:768
    s_branch K2_te0l
K2_tu0l:
    v_cvt_pk_bf16_f32 v12, v12, v13
    v_cvt_pk_bf16_f32 v14, v14, v15
    ds_write_b16 v8, v12 offset:0
    ds_write_b16_d16_hi v8, v12 offset:256
    ds_write_b16 v8, v14 offset:512
    ds_write_b16_d16_hi v8, v14 offset:768
K2_te0l:
    s_waitcnt lgkmcnt(4)
    v_mfma_f32_16x16x32_bf16 v[12:15], v[32:35], v[16:19], 0
    v_mfma_f32_16x16x32_bf16 v[12:15], v[36:39], v[20:23], v[12:15]
    v_mfma_f32_16x16x32_bf16 v[12:15], v[40:43], v[24:27], v[12:15]
    v_mfma_f32_16x16x32_bf16 v[12:15], v[44:47], v[28:31], v[12:15]
    ds_read_b128 v[32:35], v9 offset:49872
    ds_read_b128 v[36:39], v9 offset:49936
    ds_read_b128 v[40:43], v9 offset:50000
    ds_read_b128 v[44:47], v9 offset:50064
    s_nop 3
    s_cmp_lg_u32 s61, 0
    s_cbranch_scc1 K2_tu1l
    v_fma_f32 v12, v12, s62, v68
    v_fma_f32 v13, v13, s62, v68
    v_fma_f32 v14, v14, s62, v68
    v_fma_f32 v15, v15, s62, v68
    ds_write_b32 v8, v12 offset:4096
    ds_write_b32 v8, v13 offset:4352
    ds_write_b32 v8, v14 offset:4608
    ds_write_b32 v8, v15 offset:4864
    s_branch K2_te1l
K2_tu1l:
    v_cvt_pk_bf16_f32 v12, v12, v13
    v_cvt_pk_bf16_f32 v14, v14, v15
    ds_write_b16 v8, v12 offset:4096
    ds_write_b16_d16_hi v8, v12 offset:4352
    ds_write_b16 v8, v14 offset:4608
    ds_write_b16_d16_hi v8, v14 offset:4864
K2_te1l:
    s_waitcnt lgkmcnt(4)
    v_mfma_f32_16x16x32_bf16 v[12:15], v[32:35], v[16:19], 0
    v_mfma_f32_16x16x32_bf16 v[12:15], v[36:39], v[20:23], v[12:15]
    v_mfma_f32_16x16x32_bf16 v[12:15], v[40:43], v[24:27], v[12:15]
    v_mfma_f32_16x16x32_bf16 v[12:15], v[44:47], v[28:31], v[12:15]
    s_nop 7
    s_mov_b64 exec, 0xffff
    s_cmp_lg_u32 s61, 0
    s_cbranch_scc1 K2_tu2l
    v_fma_f32 v12, v12, s62, v68
    v_fma_f32 v13, v13, s62, v68
    ds_write_b32 v8, v12 offset:8192
    ds_write_b32 v8, v13 offset:8448
    s_branch K2_te2l
K2_tu2l:
    v_cvt_pk_bf16_f32 v12, v12, v13
    ds_write_b16 v8, v12 offset:8192
    ds_write_b16_d16_hi v8, v12 offset:8448
K2_te2l:
    s_mov_b64 exec, -1
    v_lshlrev_b32 v24, 3, v1
    ds_read_b64 v[68:69], v24 offset:50416
    v_mov_b32 v40, 0
    v_mov_b32 v41, 0
    v_mov_b32 v42, 0
    v_mov_b32 v43, 0
    v_mov_b32 v32, 0
    v_mov_b32 v36, 0x538637bd
    v_mov_b32 v33, 0
    v_mov_b32 v37, 0x538637bd
    v_mov_b32 v34, 0
    v_mov_b32 v38, 0x538637bd
    v_mov_b32 v35, 0
    v_mov_b32 v39, 0x538637bd
    v_mov_b32 v30, 8
    v_and_b32 v14, 31, v0
    v_lshrrev_b32 v15, 5, v0
    v_lshlrev_b32 v12, 2, v14
    v_lshlrev_b32 v13, 3, v15
    v_lshlrev_b32 v15, 1, v15
    v_sub_u32 v14, v14, v15
    v_add_u32 v15, -1, v14
    s_lshl_b32 s58, s48, 2
    s_mov_b32 s65, 0x45673210
    s_cmp_gt_u32 s51, 32
    s_cselect_b32 s65, 0x67453210, s65
    s_lshr_b32 s58, s65, s58
    s_and_b32 s58, s58, 15
    s_lshl_b32 s58, s58, 2
    v_add_lshl_u32 v17, s58, v4, 2
    v_lshrrev_b32 v18, 2, v3
    v_add_lshl_u32 v18, s58, v18, 2
    s_lshl_b32 s65, s48, 8
    v_lshl_add_u32 v19, v1, 2, s65
    v_and_b32 v16, 31, v1
    v_add_u32 v16, 12512, v16
    v_mov_b32 v20, 512
    v_mov_b32 v21, 5200
    v_add_u32 v31, s78, v75
    s_mov_b32 s77, s79
    s_mov_b32 s28, s10
    s_mov_b32 s29, s11
    s_mov_b32 s30, 0x620000
    s_mov_b32 s31, 0x00020000
    s_and_b32 s59, s2, 31
    s_lshl_b32 s59, s59, 9
    s_movk_i32 s63, 136
    s_movk_i32 s62, 544
    s_sub_u32 s76, 39, s48
    s_cmp_lt_u32 s76, s51
    s_cselect_b32 s76, 2, 0
    s_mov_b32 s3, 0
K2_tpoll:
    buffer_load_dwordx2 v[62:63], v7, s[12:15], s49 offen sc1
K2_tchk:
    s_add_u32 s3, s3, 1
    s_cmp_gt_u32 s3, 30000
    s_cbranch_scc1 K2_done0
    s_waitcnt vmcnt(0) lgkmcnt(0)
    v_cmp_ne_u32 vcc, s43, v63
    s_cbranch_vccz K2_tok
    s_mov_b64 exec, vcc
    s_sleep 4
    s_branch K2_tpoll
K2_tok:
    s_mov_b64 exec, -1
    s_setprio 3
    v_lshrrev_b32 v11, 16, v62
    v_and_b32 v5, 0xffff, v62
    v_add_u32 v7, v11, v2
    v_sub_u32 v5, v5, v2
    v_mad_u32_u24 v7, v7, 12, v6
    v_cmp_lt_i32 s[74:75], 16, v5
    v_cmp_lt_i32 s[72:73], 12, v5
    v_cmp_lt_i32 s[66:67], 0, v5
    v_cmp_lt_i32 s[68:69], 4, v5
    v_cmp_lt_i32 s[70:71], 8, v5
    s_mov_b64 exec, s[74:75]
    s_cbranch_execz K2_nr4l
    buffer_load_dwordx3 v[64:66], v7, s[16:19], 0 offen offset:192 sc1
K2_nr4l:
    s_mov_b64 exec, s[72:73]
    s_cbranch_execz K2_nr3l
    buffer_load_dwordx3 v[60:62], v7, s[16:19], 0 offen offset:144 sc1
K2_nr3l:
    s_mov_b64 exec, s[66:67]
    buffer_load_dwordx3 v[48:50], v7, s[16:19], 0 offen offset:0 sc1
    s_mov_b64 exec, s[68:69]
    buffer_load_dwordx3 v[52:54], v7, s[16:19], 0 offen offset:48 sc1
    s_mov_b64 exec, s[70:71]
    buffer_load_dwordx3 v[56:58], v7, s[16:19], 0 offen offset:96 sc1
    s_mov_b64 exec, -1
K2_rk:
    s_waitcnt vmcnt(3)
    s_mov_b64 exec, s[72:73]
    v_lshrrev_b32 v28, 16, v62
    ds_add_rtn_u32 v63, v28, v30 offset:0
    s_waitcnt vmcnt(2)
    s_mov_b64 exec, s[66:67]
    v_lshrrev_b32 v25, 16, v50
    ds_add_rtn_u32 v51, v25, v30 offset:0
    s_waitcnt vmcnt(1)
    s_mov_b64 exec, s[68:69]
    v_lshrrev_b32 v26, 16, v54
    ds_add_rtn_u32 v55, v26, v30 offset:0
    s_waitcnt vmcnt(0)
    s_mov_b64 exec, s[70:71]
    v_lshrrev_b32 v27, 16, v58
    ds_add_rtn_u32 v59, v27, v30 offset:0
    s_waitcnt lgkmcnt(3)
    s_mov_b64 exec, s[72:73]
    v_min_u32 v63, s42, v63
    v_mad_u32_u24 v10, v28, s63, v63
    v_lshrrev_b32 v28, 2, v10
    ds_write_b64 v10, v[60:61] offset:5200
    ds_write_b16 v28, v62 offset:512
    s_waitcnt lgkmcnt(4)
    s_mov_b64 exec, s[66:67]
    v_min_u32 v51, s42, v51
    v_mad_u32_u24 v11, v25, s63, v51
    v_lshrrev_b32 v25, 2, v11
    ds_write_b64 v11, v[48:49] offset:5200
    ds_write_b16 v25, v50 offset:512
    s_waitcnt lgkmcnt(5)
    s_mov_b64 exec, s[68:69]
    v_min_u32 v55, s42, v55
    v_mad_u32_u24 v10, v26, s63, v55
    v_lshrrev_b32 v26, 2, v10
    ds_write_b64 v10, v[52:53] offset:5200
    ds_write_b16 v26, v54 offset:512
    s_waitcnt lgkmcnt(6)
    s_mov_b64 exec, s[70:71]
    v_min_u32 v59, s42, v59
    v_mad_u32_u24 v11, v27, s63, v59
    v_lshrrev_b32 v27, 2, v11
    ds_write_b64 v11, v[56:57] offset:5200
    ds_write_b16 v27, v58 offset:512
    s_mov_b64 exec, s[74:75]
    s_cbranch_execnz K2_rem0
K2_rem_end:
    s_mov_b64 exec, -1
    s_cmp_lg_u32 s48, 0
    s_cbranch_scc1 K2_ngf
    buffer_load_dwordx2 v[22:23], v24, s[20:23], s59 offen sc1
K2_ngf:
    s_mov_b32 s75, s78
    s_mov_b32 s67, 0
    s_waitcnt lgkmcnt(0)
    s_barrier
    ds_read_b32 v8, v12 offset:0
    ds_read_b64 v[10:11], v13 offset:0
    s_waitcnt lgkmcnt(0)
    v_lshlrev_b32 v9, 2, v8
    v_lshl_add_u32 v10, v10, 2, v14
    v_lshl_add_u32 v11, v11, 2, v15
    v_cmp_gt_i32 vcc, v10, v9
    v_cmp_gt_i32 s[44:45], v11, v9
    v_min_u32 v8, 0x7fff8, v8
    v_cndmask_b32 v10, 0, 4, vcc
    v_cndmask_b32 v11, 0, 4, s[44:45]
    v_lshl_or_b32 v8, v8, 5, v1
    v_add_u32 v10, v10, v11
    ds_add_u32 v12, v10 offset:256
    s_cmp_lg_u32 s48, 0
    s_cbranch_scc1 K2_gok
    s_mov_b32 s3, 0
K2_gpoll:
    s_waitcnt vmcnt(0)
    v_cmp_ne_u32 vcc, s43, v22
    v_cmp_ne_u32 s[44:45], s43, v23
    s_or_b64 vcc, vcc, s[44:45]
    s_cbranch_scc0 K2_gok
    s_add_u32 s3, s3, 1
    s_cmp_gt_u32 s3, 30000
    s_cbranch_scc1 K2_done0
    s_sleep 4
    buffer_load_dwordx2 v[22:23], v24, s[20:23], s59 offen sc1
    s_branch K2_gpoll
K2_gok:
    s_waitcnt lgkmcnt(0)
    s_barrier
    ds_read_b32 v13, v12 offset:256
    s_mov_b32 exec_hi, 0
    s_waitcnt lgkmcnt(0)
    ds_permute_b32 v14, v13, v8
    s_mov_b64 exec, -1
    s_waitcnt lgkmcnt(0)
    ds_bpermute_b32 v15, v17, v14
    ds_bpermute_b32 v13, v18, v14
    v_readlane_b32 s68, v14, s58
    s_lshr_b32 s68, s68, 8
    s_min_u32 s68, s68, 64
    s_add_u32 s68, s68, 1
    s_lshr_b32 s68, s68, 1
    s_max_u32 s68, s68, 4
    s_lshl_b32 s65, s68, 1
    s_waitcnt lgkmcnt(0)
    ds_write_b32 v19, v15 offset:50928
    v_lshrrev_b32 v17, 8, v15
    v_and_b32 v15, 0xff, v15
    v_and_b32 v13, 0xff, v13
    v_mad_u32_u24 v78, v15, s63, v20
    v_mad_u32_u24 v79, v13, s62, v21
    v_add_u32 v17, v17, v3
    v_lshl_add_u32 v44, v15, 8, v31
    v_lshl_add_u32 v18, v17, 1, v78
    v_cmp_gt_u32 vcc, s65, v17
    v_lshlrev_b32 v19, 2, v18
    s_and_b64 exec, exec, vcc
    s_cbranch_execz K2_padd
    ds_write_b16 v18, v16 offset:0
    ds_write_b64 v19, v[40:41] offset:3152
    v_add_u32 v17, 16, v17
    v_cmp_gt_u32 vcc, s65, v17
    s_and_b64 exec, exec, vcc
    s_cbranch_execz K2_padd
    ds_write_b16 v18, v16 offset:32
    ds_write_b64 v19, v[40:41] offset:3280
    v_add_u32 v17, 16, v17
    v_cmp_gt_u32 vcc, s65, v17
    s_and_b64 exec, exec, vcc
    s_cbranch_execz K2_padd
    ds_write_b16 v18, v16 offset:64
    ds_write_b64 v19, v[40:41] offset:3408
    v_add_u32 v17, 16, v17
    v_cmp_gt_u32 vcc, s65, v17
    s_and_b64 exec, exec, vcc
    s_cbranch_execz K2_padd
    ds_write_b16 v18, v16 offset:96
    ds_write_b64 v19, v[40:41] offset:3536
K2_padd:
    s_mov_b64 exec, -1
K2_run:
    ds_read_u16 v48, v78 offset:0
    ds_read_u16 v49, v78 offset:2
    ds_read_u16 v50, v78 offset:4
    ds_read_u16 v51, v78 offset:6
    ds_read_u16 v52, v78 offset:8
    ds_read_u16 v53, v78 offset:10
    ds_read_u16 v54, v78 offset:12
    ds_read_u16 v55, v78 offset:14
    s_mov_b64 exec, s[40:41]
    ds_read_b64 v[40:41], v79 offset:0
    ds_read_b64 v[42:43], v79 offset:8
    s_mov_b64 exec, -1
    ds_read_b128 v[64:67], v44
    s_sub_u32 s65, s68, 4
    s_add_u32 s64, s65, 3
    s_lshr_b32 s64, s64, 2
    s_sub_u32 s65, 0, s65
    s_and_b32 s65, s65, 3
    s_lshl_b32 s66, s65, 2
    v_subrev_u32 v78, s66, v78
    s_lshl_b32 s66, s65, 4
    v_subrev_u32 v79, s66, v79
    s_waitcnt lgkmcnt(3)
    v_lshl_add_u32 v48, v48, 9, v75
    v_lshl_add_u32 v49, v49, 9, v75
    v_lshl_add_u32 v50, v50, 9, v75
    v_lshl_add_u32 v51, v51, 9, v75
    v_lshl_add_u32 v52, v52, 9, v75
    v_lshl_add_u32 v53, v53, 9, v75
    v_lshl_add_u32 v54, v54, 9, v75
    v_lshl_add_u32 v55, v55, 9, v75
    s_waitcnt lgkmcnt(0)
    s_cmp_eq_u32 s65, 1
    s_cbranch_scc1 K2_fill1
    s_cmp_eq_u32 s65, 2
    s_cbranch_scc1 K2_fill2
    s_cmp_eq_u32 s65, 3
    s_cbranch_scc1 K2_fill3
    buffer_load_dwordx4 v[0:3], v48, s[28:31], 0 offen sc1
    buffer_load_dwordx4 v[4:7], v49, s[28:31], 0 offen sc1
    buffer_load_dwordx4 v[8:11], v50, s[28:31], 0 offen sc1
    buffer_load_dwordx4 v[12:15], v51, s[28:31], 0 offen sc1
    buffer_load_dwordx4 v[16:19], v52, s[28:31], 0 offen sc1
    buffer_load_dwordx4 v[20:23], v53, s[28:31], 0 offen sc1
    buffer_load_dwordx4 v[24:27], v54, s[28:31], 0 offen sc1
    buffer_load_dwordx4 v[28:31], v55, s[28:31], 0 offen sc1
    s_waitcnt vmcnt(6)
    v_mfma_f32_16x16x32_bf16 v[48:51], v[70:73], v[0:3], v[64:67]
    v_mfma_f32_16x16x32_bf16 v[52:55], v[70:73], v[4:7], v[64:67]
    s_nop 4
    v_mfma_f32_16x16x16_bf16 v[48:51], v[40:41], v[68:69], v[48:51]
    v_mfma_f32_16x16x16_bf16 v[52:55], v[42:43], v[68:69], v[52:55]
    s_nop 1
    s_mov_b64 exec, s[40:41]
    ds_read_b64 v[40:41], v79 offset:16
    ds_read_b64 v[42:43], v79 offset:24
    s_mov_b64 exec, -1
    ds_read_u16 v74, v78 offset:16
    ds_read_u16 v76, v78 offset:18
    s_cmp_eq_u32 s64, 0
    s_cbranch_scc1 K2_drain
K2_b0:
    s_waitcnt vmcnt(4)
    v_mfma_f32_16x16x32_bf16 v[56:59], v[70:73], v[8:11], v[64:67]
    v_exp_f32 v48, v48 clamp
    v_exp_f32 v49, v49 clamp
    v_mfma_f32_16x16x32_bf16 v[60:63], v[70:73], v[12:15], v[64:67]
    v_exp_f32 v50, v50 clamp
    v_exp_f32 v51, v51 clamp
    v_exp_f32 v52, v52 clamp
    v_exp_f32 v53, v53 clamp
    s_waitcnt lgkmcnt(2)
    v_mfma_f32_16x16x16_bf16 v[56:59], v[40:41], v[68:69], v[56:59]
    v_exp_f32 v54, v54 clamp
    v_exp_f32 v55, v55 clamp
    v_pk_add_f32 v[48:49], v[48:49], s[56:57]
    v_pk_add_f32 v[50:51], v[50:51], s[56:57]
    v_pk_add_f32 v[52:53], v[52:53], s[56:57]
    v_pk_add_f32 v[54:55], v[54:55], s[56:57]
    v_pk_mul_f32 v[44:45], v[48:49], v[52:53]
    v_pk_mul_f32 v[46:47], v[50:51], v[54:55]
    v_pk_mul_f32 v[0:1], v[0:1], v[52:53]
    v_pk_mul_f32 v[2:3], v[2:3], v[54:55]
    v_mfma_f32_16x16x16_bf16 v[60:63], v[42:43], v[68:69], v[60:63]
    v_rcp_f32 v44, v44
    v_rcp_f32 v45, v45
    v_rcp_f32 v46, v46
    v_rcp_f32 v47, v47
    v_pk_fma_f32 v[0:1], v[4:5], v[48:49], v[0:1]
    v_pk_fma_f32 v[2:3], v[6:7], v[50:51], v[2:3]
    v_pk_add_f32 v[48:49], v[48:49], v[52:53]
    v_pk_add_f32 v[50:51], v[50:51], v[54:55]
    v_pk_fma_f32 v[32:33], v[0:1], v[44:45], v[32:33]
    v_pk_fma_f32 v[34:35], v[2:3], v[46:47], v[34:35]
    v_pk_fma_f32 v[36:37], v[48:49], v[44:45], v[36:37]
    v_pk_fma_f32 v[38:39], v[50:51], v[46:47], v[38:39]
    s_waitcnt lgkmcnt(0)
    buffer_load_dwordx4 v[0:3], v[74:75], s[24:27], 0 idxen offen sc1
    buffer_load_dwordx4 v[4:7], v[76:77], s[24:27], 0 idxen offen sc1
    s_mov_b64 exec, s[40:41]
    ds_read_b64 v[40:41], v79 offset:32
    ds_read_b64 v[42:43], v79 offset:40
    s_mov_b64 exec, -1
    ds_read_u16 v74, v78 offset:20
    ds_read_u16 v76, v78 offset:22
K2_b1:
    s_waitcnt vmcnt(4)
    v_mfma_f32_16x16x32_bf16 v[48:51], v[70:73], v[16:19], v[64:67]
    v_exp_f32 v56, v56 clamp
    v_exp_f32 v57, v57 clamp
    v_mfma_f32_16x16x32_bf16 v[52:55], v[70:73], v[20:23], v[64:67]
    v_exp_f32 v58, v58 clamp
    v_exp_f32 v59, v59 clamp
    v_exp_f32 v60, v60 clamp
    v_exp_f32 v61, v61 clamp
    s_waitcnt lgkmcnt(2)
    v_mfma_f32_16x16x16_bf16 v[48:51], v[40:41], v[68:69], v[48:51]
    v_exp_f32 v62, v62 clamp
    v_exp_f32 v63, v63 clamp
    v_pk_add_f32 v[56:57], v[56:57], s[56:57]
    v_pk_add_f32 v[58:59], v[58:59], s[56:57]
    v_pk_add_f32 v[60:61], v[60:61], s[56:57]
    v_pk_add_f32 v[62:63], v[62:63], s[56:57]
    v_pk_mul_f32 v[44:45], v[56:57], v[60:61]
    v_pk_mul_f32 v[46:47], v[58:59], v[62:63]
    v_pk_mul_f32 v[8:9], v[8:9], v[60:61]
    v_pk_mul_f32 v[10:11], v[10:11], v[62:63]
    v_mfma_f32_16x16x16_bf16 v[52:55], v[42:43], v[68:69], v[52:55]
    v_rcp_f32 v44, v44
    v_rcp_f32 v45, v45
    v_rcp_f32 v46, v46
    v_rcp_f32 v47, v47
    v_pk_fma_f32 v[8:9], v[12:13], v[56:57], v[8:9]
    v_pk_fma_f32 v[10:11], v[14:15], v[58:59], v[10:11]
    v_pk_add_f32 v[56:57], v[56:57], v[60:61]
    v_pk_add_f32 v[58:59], v[58:59], v[62:63]
    v_pk_fma_f32 v[32:33], v[8:9], v[44:45], v[32:33]
    v_pk_fma_f32 v[34:35], v[10:11], v[46:47], v[34:35]
    v_pk_fma_f32 v[36:37], v[56:57], v[44:45], v[36:37]
    v_pk_fma_f32 v[38:39], v[58:59], v[46:47], v[38:39]
    s_waitcnt lgkmcnt(0)
    buffer_load_dwordx4 v[8:11], v[74:75], s[24:27], 0 idxen offen sc1
    buffer_load_dwordx4 v[12:15], v[76:77], s[24:27], 0 idxen offen sc1
    s_mov_b64 exec, s[40:41]
    ds_read_b64 v[40:41], v79 offset:48
    ds_read_b64 v[42:43], v79 offset:56
    s_mov_b64 exec, -1
    ds_read_u16 v74, v78 offset:24
    ds_read_u16 v76, v78 offset:26
K2_b2:
    s_waitcnt vmcnt(4)
    v_mfma_f32_16x16x32_bf16 v[56:59], v[70:73], v[24:27], v[64:67]
    v_exp_f32 v48, v48 clamp
    v_exp_f32 v49, v49 clamp
    v_mfma_f32_16x16x32_bf16 v[60:63], v[70:73], v[28:31], v[64:67]
    v_exp_f32 v50, v50 clamp
    v_exp_f32 v51, v51 clamp
    v_exp_f32 v52, v52 clamp
    v_exp_f32 v53, v53 clamp
    s_waitcnt lgkmcnt(2)
    v_mfma_f32_16x16x16_bf16 v[56:59], v[40:41], v[68:69], v[56:59]
    v_exp_f32 v54, v54 clamp
    v_exp_f32 v55, v55 clamp
    v_pk_add_f32 v[48:49], v[48:49], s[56:57]
    v_pk_add_f32 v[50:51], v[50:51], s[56:57]
    v_pk_add_f32 v[52:53], v[52:53], s[56:57]
    v_pk_add_f32 v[54:55], v[54:55], s[56:57]
    v_pk_mul_f32 v[44:45], v[48:49], v[52:53]
    v_pk_mul_f32 v[46:47], v[50:51], v[54:55]
    v_pk_mul_f32 v[16:17], v[16:17], v[52:53]
    v_pk_mul_f32 v[18:19], v[18:19], v[54:55]
    v_mfma_f32_16x16x16_bf16 v[60:63], v[42:43], v[68:69], v[60:63]
    v_rcp_f32 v44, v44
    v_rcp_f32 v45, v45
    v_rcp_f32 v46, v46
    v_rcp_f32 v47, v47
    v_pk_fma_f32 v[16:17], v[20:21], v[48:49], v[16:17]
    v_pk_fma_f32 v[18:19], v[22:23], v[50:51], v[18:19]
    v_pk_add_f32 v[48:49], v[48:49], v[52:53]
    v_pk_add_f32 v[50:51], v[50:51], v[54:55]
    v_pk_fma_f32 v[32:33], v[16:17], v[44:45], v[32:33]
    v_pk_fma_f32 v[34:35], v[18:19], v[46:47], v[34:35]
    v_pk_fma_f32 v[36:37], v[48:49], v[44:45], v[36:37]
    v_pk_fma_f32 v[38:39], v[50:51], v[46:47], v[38:39]
    s_waitcnt lgkmcnt(0)
    buffer_load_dwordx4 v[16:19], v[74:75], s[24:27], 0 idxen offen sc1
    buffer_load_dwordx4 v[20:23], v[76:77], s[24:27], 0 idxen offen sc1
    s_mov_b64 exec, s[40:41]
    ds_read_b64 v[40:41], v79 offset:64
    ds_read_b64 v[42:43], v79 offset:72
    s_mov_b64 exec, -1
    ds_read_u16 v74, v78 offset:28
    ds_read_u16 v76, v78 offset:30
K2_b3:
    s_waitcnt vmcnt(4)
    v_mfma_f32_16x16x32_bf16 v[48:51], v[70:73], v[0:3], v[64:67]
    v_exp_f32 v56, v56 clamp
    v_exp_f32 v57, v57 clamp
    v_mfma_f32_16x16x32_bf16 v[52:55], v[70:73], v[4:7], v[64:67]
    v_exp_f32 v58, v58 clamp
    v_exp_f32 v59, v59 clamp
    v_exp_f32 v60, v60 clamp
    v_exp_f32 v61, v61 clamp
    s_waitcnt lgkmcnt(2)
    v_mfma_f32_16x16x16_bf16 v[48:51], v[40:41], v[68:69], v[48:51]
    v_exp_f32 v62, v62 clamp
    v_exp_f32 v63, v63 clamp
    v_pk_add_f32 v[56:57], v[56:57], s[56:57]
    v_pk_add_f32 v[58:59], v[58:59], s[56:57]
    v_pk_add_f32 v[60:61], v[60:61], s[56:57]
    v_pk_add_f32 v[62:63], v[62:63], s[56:57]
    v_pk_mul_f32 v[44:45], v[56:57], v[60:61]
    v_pk_mul_f32 v[46:47], v[58:59], v[62:63]
    v_pk_mul_f32 v[24:25], v[24:25], v[60:61]
    v_pk_mul_f32 v[26:27], v[26:27], v[62:63]
    v_mfma_f32_16x16x16_bf16 v[52:55], v[42:43], v[68:69], v[52:55]
    v_rcp_f32 v44, v44
    v_rcp_f32 v45, v45
    v_rcp_f32 v46, v46
    v_rcp_f32 v47, v47
    v_pk_fma_f32 v[24:25], v[28:29], v[56:57], v[24:25]
    v_pk_fma_f32 v[26:27], v[30:31], v[58:59], v[26:27]
    v_pk_add_f32 v[56:57], v[56:57], v[60:61]
    v_pk_add_f32 v[58:59], v[58:59], v[62:63]
    v_pk_fma_f32 v[32:33], v[24:25], v[44:45], v[32:33]
    v_pk_fma_f32 v[34:35], v[26:27], v[46:47], v[34:35]
    v_pk_fma_f32 v[36:37], v[56:57], v[44:45], v[36:37]
    v_pk_fma_f32 v[38:39], v[58:59], v[46:47], v[38:39]
    s_waitcnt lgkmcnt(0)
    buffer_load_dwordx4 v[24:27], v[74:75], s[24:27], 0 idxen offen sc1
    buffer_load_dwordx4 v[28:31], v[76:77], s[24:27], 0 idxen offen sc1
    s_mov_b64 exec, s[40:41]
    ds_read_b64 v[40:41], v79 offset:80
    ds_read_b64 v[42:43], v79 offset:88
    s_mov_b64 exec, -1
    ds_read_u16 v74, v78 offset:32
    ds_read_u16 v76, v78 offset:34
    v_add_u32 v78, 16, v78
    v_add_u32 v79, 64, v79
    s_sub_u32 s64, s64, 1
    s_add_u32 s65, s64, s76
    s_cmp_gt_u32 s65, 2
    s_cbranch_scc1 K2_b0
    s_setprio 2
    s_cmp_eq_u32 s65, 2
    s_cbranch_scc1 K2_bchk
    s_setprio 1
    s_cmp_eq_u32 s65, 1
    s_cbranch_scc1 K2_bchk
    s_setprio 0
K2_bchk:
    s_cmp_lg_u32 s64, 0
    s_cbranch_scc1 K2_b0
K2_drain:
    s_waitcnt vmcnt(4)
    v_mfma_f32_16x16x32_bf16 v[56:59], v[70:73], v[8:11], v[64:67]
    v_exp_f32 v48, v48 clamp
    v_exp_f32 v49, v49 clamp
    v_mfma_f32_16x16x32_bf16 v[60:63], v[70:73], v[12:15], v[64:67]
    v_exp_f32 v50, v50 clamp
    v_exp_f32 v51, v51 clamp
    v_exp_f32 v52, v52 clamp
    v_exp_f32 v53, v53 clamp
    s_waitcnt lgkmcnt(2)
    v_mfma_f32_16x16x16_bf16 v[56:59], v[40:41], v[68:69], v[56:59]
    v_exp_f32 v54, v54 clamp
    v_exp_f32 v55, v55 clamp
    v_pk_add_f32 v[48:49], v[48:49], s[56:57]
    v_pk_add_f32 v[50:51], v[50:51], s[56:57]
    v_pk_add_f32 v[52:53], v[52:53], s[56:57]
    v_pk_add_f32 v[54:55], v[54:55], s[56:57]
    v_pk_mul_f32 v[44:45], v[48:49], v[52:53]
    v_pk_mul_f32 v[46:47], v[50:51], v[54:55]
    v_pk_mul_f32 v[0:1], v[0:1], v[52:53]
    v_pk_mul_f32 v[2:3], v[2:3], v[54:55]
    v_mfma_f32_16x16x16_bf16 v[60:63], v[42:43], v[68:69], v[60:63]
    v_rcp_f32 v44, v44
    v_rcp_f32 v45, v45
    v_rcp_f32 v46, v46
    v_rcp_f32 v47, v47
    v_pk_fma_f32 v[0:1], v[4:5], v[48:49], v[0:1]
    v_pk_fma_f32 v[2:3], v[6:7], v[50:51], v[2:3]
    v_pk_add_f32 v[48:49], v[48:49], v[52:53]
    v_pk_add_f32 v[50:51], v[50:51], v[54:55]
    v_pk_fma_f32 v[32:33], v[0:1], v[44:45], v[32:33]
    v_pk_fma_f32 v[34:35], v[2:3], v[46:47], v[34:35]
    v_pk_fma_f32 v[36:37], v[48:49], v[44:45], v[36:37]
    v_pk_fma_f32 v[38:39], v[50:51], v[46:47], v[38:39]
    s_mov_b64 exec, s[40:41]
    ds_read_b64 v[40:41], v79 offset:32
    ds_read_b64 v[42:43], v79 offset:40
    s_mov_b64 exec, -1
    s_waitcnt vmcnt(2)
    v_mfma_f32_16x16x32_bf16 v[48:51], v[70:73], v[16:19], v[64:67]
    v_exp_f32 v56, v56 clamp
    v_exp_f32 v57, v57 clamp
    v_mfma_f32_16x16x32_bf16 v[52:55], v[70:73], v[20:23], v[64:67]
    v_exp_f32 v58, v58 clamp
    v_exp_f32 v59, v59 clamp
    v_exp_f32 v60, v60 clamp
    v_exp_f32 v61, v61 clamp
    s_waitcnt lgkmcnt(0)
    v_mfma_f32_16x16x16_bf16 v[48:51], v[40:41], v[68:69], v[48:51]
    v_exp_f32 v62, v62 clamp
    v_exp_f32 v63, v63 clamp
    v_pk_add_f32 v[56:57], v[56:57], s[56:57]
    v_pk_add_f32 v[58:59], v[58:59], s[56:57]
    v_pk_add_f32 v[60:61], v[60:61], s[56:57]
    v_pk_add_f32 v[62:63], v[62:63], s[56:57]
    v_pk_mul_f32 v[44:45], v[56:57], v[60:61]
    v_pk_mul_f32 v[46:47], v[58:59], v[62:63]
    v_pk_mul_f32 v[8:9], v[8:9], v[60:61]
    v_pk_mul_f32 v[10:11], v[10:11], v[62:63]
    v_mfma_f32_16x16x16_bf16 v[52:55], v[42:43], v[68:69], v[52:55]
    v_rcp_f32 v44, v44
    v_rcp_f32 v45, v45
    v_rcp_f32 v46, v46
    v_rcp_f32 v47, v47
    v_pk_fma_f32 v[8:9], v[12:13], v[56:57], v[8:9]
    v_pk_fma_f32 v[10:11], v[14:15], v[58:59], v[10:11]
    v_pk_add_f32 v[56:57], v[56:57], v[60:61]
    v_pk_add_f32 v[58:59], v[58:59], v[62:63]
    v_pk_fma_f32 v[32:33], v[8:9], v[44:45], v[32:33]
    v_pk_fma_f32 v[34:35], v[10:11], v[46:47], v[34:35]
    v_pk_fma_f32 v[36:37], v[56:57], v[44:45], v[36:37]
    v_pk_fma_f32 v[38:39], v[58:59], v[46:47], v[38:39]
    s_mov_b64 exec, s[40:41]
    ds_read_b64 v[40:41], v79 offset:48
    ds_read_b64 v[42:43], v79 offset:56
    s_mov_b64 exec, -1
    s_waitcnt vmcnt(0)
    v_mfma_f32_16x16x32_bf16 v[56:59], v[70:73], v[24:27], v[64:67]
    v_exp_f32 v48, v48 clamp
    v_exp_f32 v49, v49 clamp
    v_mfma_f32_16x16x32_bf16 v[60:63], v[70:73], v[28:31], v[64:67]
    v_exp_f32 v50, v50 clamp
    v_exp_f32 v51, v51 clamp
    v_exp_f32 v52, v52 clamp
    v_exp_f32 v53, v53 clamp
    s_waitcnt lgkmcnt(0)
    v_mfma_f32_16x16x16_bf16 v[56:59], v[40:41], v[68:69], v[56:59]
    v_exp_f32 v54, v54 clamp
    v_exp_f32 v55, v55 clamp
    v_pk_add_f32 v[48:49], v[48:49], s[56:57]
    v_pk_add_f32 v[50:51], v[50:51], s[56:57]
    v_pk_add_f32 v[52:53], v[52:53], s[56:57]
    v_pk_add_f32 v[54:55], v[54:55], s[56:57]
    v_pk_mul_f32 v[44:45], v[48:49], v[52:53]
    v_pk_mul_f32 v[46:47], v[50:51], v[54:55]
    v_pk_mul_f32 v[16:17], v[16:17], v[52:53]
    v_pk_mul_f32 v[18:19], v[18:19], v[54:55]
    v_mfma_f32_16x16x16_bf16 v[60:63], v[42:43], v[68:69], v[60:63]
    v_rcp_f32 v44, v44
    v_rcp_f32 v45, v45
    v_rcp_f32 v46, v46
    v_rcp_f32 v47, v47
    v_pk_fma_f32 v[16:17], v[20:21], v[48:49], v[16:17]
    v_pk_fma_f32 v[18:19], v[22:23], v[50:51], v[18:19]
    v_pk_add_f32 v[48:49], v[48:49], v[52:53]
    v_pk_add_f32 v[50:51], v[50:51], v[54:55]
    v_pk_fma_f32 v[32:33], v[16:17], v[44:45], v[32:33]
    v_pk_fma_f32 v[34:35], v[18:19], v[46:47], v[34:35]
    v_pk_fma_f32 v[36:37], v[48:49], v[44:45], v[36:37]
    v_pk_fma_f32 v[38:39], v[50:51], v[46:47], v[38:39]
    v_exp_f32 v56, v56 clamp
    v_exp_f32 v57, v57 clamp
    v_exp_f32 v58, v58 clamp
    v_exp_f32 v59, v59 clamp
    v_exp_f32 v60, v60 clamp
    v_exp_f32 v61, v61 clamp
    v_exp_f32 v62, v62 clamp
    v_exp_f32 v63, v63 clamp
    v_pk_add_f32 v[56:57], v[56:57], s[56:57]
    v_pk_add_f32 v[58:59], v[58:59], s[56:57]
    v_pk_add_f32 v[60:61], v[60:61], s[56:57]
    v_pk_add_f32 v[62:63], v[62:63], s[56:57]
    v_pk_mul_f32 v[44:45], v[56:57], v[60:61]
    v_pk_mul_f32 v[46:47], v[58:59], v[62:63]
    v_pk_mul_f32 v[24:25], v[24:25], v[60:61]
    v_pk_mul_f32 v[26:27], v[26:27], v[62:63]
    v_rcp_f32 v44, v44
    v_rcp_f32 v45, v45
    v_rcp_f32 v46, v46
    v_rcp_f32 v47, v47
    v_pk_fma_f32 v[24:25], v[28:29], v[56:57], v[24:25]
    v_pk_fma_f32 v[26:27], v[30:31], v[58:59], v[26:27]
    v_pk_add_f32 v[56:57], v[56:57], v[60:61]
    v_pk_add_f32 v[58:59], v[58:59], v[62:63]
    v_pk_fma_f32 v[32:33], v[24:25], v[44:45], v[32:33]
    v_pk_fma_f32 v[34:35], v[26:27], v[46:47], v[34:35]
    v_pk_fma_f32 v[36:37], v[56:57], v[44:45], v[36:37]
    v_pk_fma_f32 v[38:39], v[58:59], v[46:47], v[38:39]
    s_cmp_eq_u32 s67, 0
    s_cbranch_scc1 K2_finA
    s_branch K2_finB
K2_fill1:
    buffer_load_dwordx4 v[8:11], v48, s[28:31], 0 offen sc1
    buffer_load_dwordx4 v[12:15], v49, s[28:31], 0 offen sc1
    buffer_load_dwordx4 v[16:19], v50, s[28:31], 0 offen sc1
    buffer_load_dwordx4 v[20:23], v51, s[28:31], 0 offen sc1
    buffer_load_dwordx4 v[24:27], v52, s[28:31], 0 offen sc1
    buffer_load_dwordx4 v[28:31], v53, s[28:31], 0 offen sc1
    buffer_load_dwordx4 v[0:3], v54, s[28:31], 0 offen sc1
    buffer_load_dwordx4 v[4:7], v55, s[28:31], 0 offen sc1
    s_waitcnt vmcnt(6)
    v_mfma_f32_16x16x32_bf16 v[56:59], v[70:73], v[8:11], v[64:67]
    v_mfma_f32_16x16x32_bf16 v[60:63], v[70:73], v[12:15], v[64:67]
    s_nop 4
    v_mfma_f32_16x16x16_bf16 v[56:59], v[40:41], v[68:69], v[56:59]
    v_mfma_f32_16x16x16_bf16 v[60:63], v[42:43], v[68:69], v[60:63]
    s_nop 1
    s_mov_b64 exec, s[40:41]
    ds_read_b64 v[40:41], v79 offset:32
    ds_read_b64 v[42:43], v79 offset:40
    s_mov_b64 exec, -1
    ds_read_u16 v74, v78 offset:20
    ds_read_u16 v76, v78 offset:22
    s_branch K2_b1
K2_fill2:
    buffer_load_dwordx4 v[16:19], v48, s[28:31], 0 offen sc1
    buffer_load_dwordx4 v[20:23], v49, s[28:31], 0 offen sc1
    buffer_load_dwordx4 v[24:27], v50, s[28:31], 0 offen sc1
    buffer_load_dwordx4 v[28:31], v51, s[28:31], 0 offen sc1
    buffer_load_dwordx4 v[0:3], v52, s[28:31], 0 offen sc1
    buffer_load_dwordx4 v[4:7], v53, s[28:31], 0 offen sc1
    buffer_load_dwordx4 v[8:11], v54, s[28:31], 0 offen sc1
    buffer_load_dwordx4 v[12:15], v55, s[28:31], 0 offen sc1
    s_waitcnt vmcnt(6)
    v_mfma_f32_16x16x32_bf16 v[48:51], v[70:73], v[16:19], v[64:67]
    v_mfma_f32_16x16x32_bf16 v[52:55], v[70:73], v[20:23], v[64:67]
    s_nop 4
    v_mfma_f32_16x16x16_bf16 v[48:51], v[40:41], v[68:69], v[48:51]
    v_mfma_f32_16x16x16_bf16 v[52:55], v[42:43], v[68:69], v[52:55]
    s_nop 1
    s_mov_b64 exec, s[40:41]
    ds_read_b64 v[40:41], v79 offset:48
    ds_read_b64 v[42:43], v79 offset:56
    s_mov_b64 exec, -1
    ds_read_u16 v74, v78 offset:24
    ds_read_u16 v76, v78 offset:26
    s_branch K2_b2
K2_fill3:
    buffer_load_dwordx4 v[24:27], v48, s[28:31], 0 offen sc1
    buffer_load_dwordx4 v[28:31], v49, s[28:31], 0 offen sc1
    buffer_load_dwordx4 v[0:3], v50, s[28:31], 0 offen sc1
    buffer_load_dwordx4 v[4:7], v51, s[28:31], 0 offen sc1
    buffer_load_dwordx4 v[8:11], v52, s[28:31], 0 offen sc1
    buffer_load_dwordx4 v[12:15], v53, s[28:31], 0 offen sc1
    buffer_load_dwordx4 v[16:19], v54, s[28:31], 0 offen sc1
    buffer_load_dwordx4 v[20:23], v55, s[28:31], 0 offen sc1
    s_waitcnt vmcnt(6)
    v_mfma_f32_16x16x32_bf16 v[56:59], v[70:73], v[24:27], v[64:67]
    v_mfma_f32_16x16x32_bf16 v[60:63], v[70:73], v[28:31], v[64:67]
    s_nop 4
    v_mfma_f32_16x16x16_bf16 v[56:59], v[40:41], v[68:69], v[56:59]
    v_mfma_f32_16x16x16_bf16 v[60:63], v[42:43], v[68:69], v[60:63]
    s_nop 1
    s_mov_b64 exec, s[40:41]
    ds_read_b64 v[40:41], v79 offset:64
    ds_read_b64 v[42:43], v79 offset:72
    s_mov_b64 exec, -1
    ds_read_u16 v74, v78 offset:28
    ds_read_u16 v76, v78 offset:30
    s_branch K2_b3
K2_finA:
    v_mbcnt_lo_u32_b32 v0, -1, 0
    v_mbcnt_hi_u32_b32 v0, -1, v0
    v_and_b32 v1, 15, v0
    v_lshrrev_b32 v2, 4, v0
    s_lshl_b32 s65, s48, 8
    v_lshl_add_u32 v3, v0, 2, s65
    ds_read_b32 v4, v3 offset:50928
    v_rcp_f32 v36, v36
    v_rcp_f32 v37, v37
    v_rcp_f32 v38, v38
    v_rcp_f32 v39, v39
    v_lshlrev_b32 v5, 3, v1
    s_waitcnt lgkmcnt(0)
    v_and_b32 v3, 0xff, v4
    v_lshl_add_u32 v3, v3, 8, v5
    ds_read_b64 v[8:9], v3 offset:32464
    ds_read_b64 v[12:13], v3 offset:32592
    v_cmp_gt_u32 vcc, 16640, v4
    s_waitcnt lgkmcnt(0)
    v_lshlrev_b32 v10, 16, v9
    v_and_b32 v11, 0xffff0000, v9
    v_and_b32 v9, 0xffff0000, v8
    v_lshlrev_b32 v8, 16, v8
    v_lshlrev_b32 v14, 16, v13
    v_and_b32 v15, 0xffff0000, v13
    v_and_b32 v13, 0xffff0000, v12
    v_lshlrev_b32 v12, 16, v12
    v_pk_fma_f32 v[8:9], v[32:33], v[36:37], v[8:9]
    v_pk_fma_f32 v[10:11], v[34:35], v[38:39], v[10:11]
    v_max_f32 v8, 0, v8
    v_max_f32 v9, 0, v9
    v_max_f32 v10, 0, v10
    v_max_f32 v11, 0, v11
    v_pk_add_f32 v[8:9], v[8:9], v[12:13]
    v_pk_add_f32 v[10:11], v[10:11], v[14:15]
    v_cvt_pk_bf16_f32 v8, v8, v9
    v_cvt_pk_bf16_f32 v9, v10, v11
    s_mov_b64 exec, vcc
    buffer_store_dwordx2 v[8:9], v3, s[52:55], s77 offen sc1
    s_mov_b64 exec, -1
    s_sub_u32 s60, 39, s48
    s_cmp_ge_u32 s60, s51
    s_cbranch_scc1 K2_slowscan
    s_lshl_b32 s65, s60, 2
    v_mov_b32 v3, s65
    ds_read_b32 v4, v3 offset:0
    v_mov_b32 v32, 0
    v_mov_b32 v36, 0x528637bd
    v_mov_b32 v33, 0
    v_mov_b32 v37, 0x528637bd
    v_mov_b32 v34, 0
    v_mov_b32 v38, 0x528637bd
    v_mov_b32 v35, 0
    v_mov_b32 v39, 0x528637bd
    s_mul_i32 s74, s60, s63
    s_mov_b32 s67, 1
    s_mov_b32 s76, 0
    s_waitcnt lgkmcnt(0)
    v_lshrrev_b32 v4, 3, v4
    s_nop 0
    v_readfirstlane_b32 s68, v4
    s_cmp_gt_u32 s68, 64
    s_cbranch_scc1 K2_slowscan
    v_add_u32 v4, v4, v0
    s_add_u32 s68, s68, 7
    s_lshr_b32 s68, s68, 3
    s_max_u32 s68, s68, 4
    s_lshl_b32 s65, s68, 3
    v_cmp_gt_u32 vcc, s65, v4
    v_lshl_add_u32 v4, v4, 1, s74
    v_lshlrev_b32 v5, 2, v4
    v_and_b32 v6, 31, v0
    v_add_u32 v6, 12512, v6
    v_mov_b32 v8, 0
    v_mov_b32 v9, 0
    s_mov_b64 exec, vcc
    ds_write_b16 v4, v6 offset:512
    ds_write_b64 v5, v[8:9] offset:5200
    s_mov_b64 exec, -1
    s_lshl_b32 s65, s68, 2
    s_lshl_b32 s66, s68, 4
    s_add_u32 s73, s74, 512
    v_mov_b32 v20, s73
    s_lshl_b32 s74, s74, 2
    s_add_u32 s74, s74, 5200
    v_mov_b32 v21, s74
    v_lshrrev_b32 v3, 2, v1
    v_mad_u32_u24 v78, v2, s65, v20
    v_mad_u32_u24 v79, v3, s66, v21
    s_lshl_b32 s65, s60, 8
    s_add_u32 s65, s65, s75
    v_add_u32 v44, s65, v75
    s_setprio 1
    s_branch K2_run
K2_finB:
    v_mbcnt_lo_u32_b32 v0, -1, 0
    v_mbcnt_hi_u32_b32 v0, -1, v0
    v_and_b32 v1, 15, v0
    v_lshrrev_b32 v2, 4, v0
    s_lshl_b32 s65, s48, 10
    s_add_u32 s65, s65, 41168
    v_lshl_add_u32 v3, v0, 4, s65
    v_lshlrev_b32 v5, 3, v1
    v_lshl_add_u32 v5, v2, 1, v5
    v_lshl_add_u32 v4, v5, 1, s65
    ds_write_b128 v3, v[32:35]
    ds_read2st64_b32 v[8:9], v4 offset0:0 offset1:1
    ds_read2st64_b32 v[10:11], v4 offset0:2 offset1:3
    ds_write_b128 v3, v[36:39]
    ds_read2st64_b32 v[12:13], v4 offset0:0 offset1:1
    ds_read2st64_b32 v[14:15], v4 offset0:2 offset1:3
    s_lshl_b32 s65, s60, 8
    v_add_u32 v3, s65, v5
    v_mov_b32 v6, 0
    v_mov_b32 v7, 0
    ds_read_u16_d16_hi v6, v3 offset:32464
    ds_read_u16_d16_hi v7, v3 offset:32592
    s_waitcnt lgkmcnt(0)
    v_pk_add_f32 v[12:13], v[12:13], v[14:15]
    v_pk_add_f32 v[8:9], v[8:9], v[10:11]
    v_add_f32 v12, v12, v13
    v_rcp_f32 v12, v12
    v_add_f32 v8, v8, v9
    v_fma_f32 v8, v8, v12, v6
    v_max_f32 v8, 0, v8
    v_add_f32 v8, v8, v7
    v_cvt_pk_bf16_f32 v8, v8, v8
    buffer_store_short v8, v3, s[52:55], s77 offen sc1
K2_slowscan:
    s_waitcnt vmcnt(0) lgkmcnt(0)
    v_mbcnt_lo_u32_b32 v0, -1, 0
    v_mbcnt_hi_u32_b32 v0, -1, v0
    v_and_b32 v1, 15, v0
    v_lshrrev_b32 v2, 4, v0
    v_lshlrev_b32 v3, 2, v0
    ds_read_b32 v4, v3 offset:0
    s_waitcnt lgkmcnt(0)
    v_cmp_lt_u32 vcc, s42, v4
    s_cmp_eq_u64 vcc, 0
    s_cbranch_scc1 K2_done
    s_mov_b64 s[78:79], vcc
    v_mov_b32 v16, 0
    v_mov_b32 v17, 0
    v_mov_b32 v18, 0
    v_mov_b32 v19, 0
    v_mov_b32 v20, 0
    v_mov_b32 v21, 0
    v_mov_b32 v22, 0
    v_mov_b32 v23, 0
K2_snode:
    s_cmp_eq_u64 s[78:79], 0
    s_cbranch_scc1 K2_done
    s_ff1_i32_b64 s60, s[78:79]
    s_bitset0_b64 s[78:79], s60
    s_and_b32 s65, s60, 7
    s_cmp_lg_u32 s65, s48
    s_cbranch_scc1 K2_snode
    s_lshl_b32 s65, s60, 8
    s_add_u32 s65, s65, s75
    v_add_u32 v44, s65, v75
    ds_read_b128 v[64:67], v44
    v_mov_b32 v32, 0
    v_mov_b32 v36, 0x528637bd
    v_mov_b32 v33, 0
    v_mov_b32 v37, 0x528637bd
    v_mov_b32 v34, 0
    v_mov_b32 v38, 0x528637bd
    v_mov_b32 v35, 0
    v_mov_b32 v39, 0x528637bd
    s_waitcnt lgkmcnt(0)
    s_lshl_b32 s61, s60, 2
    s_mov_b32 s68, 0
K2_sseg:
    s_cmp_ge_u32 s68, 128
    s_cbranch_scc1 K2_sfin
    s_lshl_b32 s69, s68, 12
    s_add_u32 s69, s69, s49
    buffer_load_dword v48, off, s[12:15], s69 sc1
    s_waitcnt vmcnt(0)
    v_readfirstlane_b32 s70, v48
    s_lshr_b32 s71, s70, 16
    s_and_b32 s70, s70, 0xffff
    s_mul_i32 s67, s68, 37504
    s_add_u32 s68, s68, 1
    s_mov_b32 s73, 0
K2_sgrp:
    s_cmp_ge_u32 s73, s70
    s_cbranch_scc1 K2_sseg
    v_mbcnt_lo_u32_b32 v48, -1, 0
    v_mbcnt_hi_u32_b32 v48, -1, v48
    v_add_u32 v49, s73, v48
    s_add_u32 s74, s71, s73
    v_add_u32 v50, s74, v48
    v_mul_u32_u24 v50, 12, v50
    v_cmp_gt_u32 vcc, s70, v49
    s_add_u32 s73, s73, 64
    v_mov_b32 v2, 0x1fc0000
    s_mov_b64 exec, vcc
    buffer_load_dwordx3 v[0:2], v50, s[16:19], s67 offen sc1
    s_mov_b64 exec, -1
    s_mul_i32 s65, s60, 136
    v_lshlrev_b32 v49, 1, v48
    v_add_u32 v49, s65, v49
    v_lshlrev_b32 v50, 2, v49
    v_mov_b32 v51, 0x30e0
    v_mov_b32 v52, 0
    v_mov_b32 v53, 0
    ds_write_b16 v49, v51 offset:512
    ds_write_b64 v50, v[52:53] offset:5200
    v_lshrrev_b32 v51, 4, v48
    v_lshl_add_u32 v78, v51, 5, s65
    v_add_u32 v78, 512, v78
    v_bfe_u32 v51, v48, 2, 2
    s_lshl_b32 s65, s65, 2
    v_lshl_add_u32 v79, v51, 7, s65
    v_add_u32 v79, 5200, v79
    s_waitcnt vmcnt(0)
    v_lshrrev_b32 v49, 16, v2
    v_cmp_eq_u32 vcc, s61, v49
    s_bcnt1_i32_b64 s64, vcc
    s_cmp_eq_u32 s64, 0
    s_cbranch_scc1 K2_sgrp
    v_mbcnt_lo_u32_b32 v3, vcc_lo, 0
    v_mbcnt_hi_u32_b32 v3, vcc_hi, v3
    v_mul_u32_u24 v3, 65, v3
    v_bfe_u32 v3, v3, 2, 6
    v_lshlrev_b32 v3, 3, v3
    s_mov_b64 exec, vcc
    v_mad_u32_u24 v50, v49, s63, v3
    v_lshrrev_b32 v49, 2, v50
    ds_write_b64 v50, v[0:1] offset:5200
    ds_write_b16 v49, v2 offset:512
    s_mov_b64 exec, -1
    s_add_u32 s64, s64, 3
    s_lshr_b32 s64, s64, 2
    s_waitcnt lgkmcnt(0)
K2_loops:
    ds_read_u16 v56, v78 offset:0
    ds_read_u16 v57, v78 offset:2
    ds_read_u16 v58, v78 offset:4
    ds_read_u16 v59, v78 offset:6
    s_mov_b64 exec, s[40:41]
    ds_read_b64 v[16:17], v79 offset:0
    ds_read_b64 v[18:19], v79 offset:8
    ds_read_b64 v[20:21], v79 offset:16
    ds_read_b64 v[22:23], v79 offset:24
    s_mov_b64 exec, -1
    s_waitcnt lgkmcnt(4)
    v_lshl_add_u32 v56, v56, 9, v75
    v_lshl_add_u32 v57, v57, 9, v75
    v_lshl_add_u32 v58, v58, 9, v75
    v_lshl_add_u32 v59, v59, 9, v75
    buffer_load_dwordx4 v[0:3], v56, s[28:31], 0 offen sc1
    buffer_load_dwordx4 v[4:7], v57, s[28:31], 0 offen sc1
    buffer_load_dwordx4 v[8:11], v58, s[28:31], 0 offen sc1
    buffer_load_dwordx4 v[12:15], v59, s[28:31], 0 offen sc1
    v_add_u32 v78, 8, v78
    v_add_u32 v79, 32, v79
    s_waitcnt vmcnt(0) lgkmcnt(0)
    v_mfma_f32_16x16x32_bf16 v[48:51], v[70:73], v[0:3], v[64:67]
    s_nop 5
    v_mfma_f32_16x16x16_bf16 v[48:51], v[16:17], v[68:69], v[48:51]
    s_nop 7
    v_exp_f32 v48, v48 clamp
    v_exp_f32 v49, v49 clamp
    v_exp_f32 v50, v50 clamp
    v_exp_f32 v51, v51 clamp
    v_pk_add_f32 v[48:49], v[48:49], s[56:57]
    v_pk_add_f32 v[50:51], v[50:51], s[56:57]
    v_rcp_f32 v48, v48
    v_rcp_f32 v49, v49
    v_rcp_f32 v50, v50
    v_rcp_f32 v51, v51
    s_nop 0
    v_pk_fma_f32 v[32:33], v[48:49], v[0:1], v[32:33]
    v_pk_fma_f32 v[34:35], v[50:51], v[2:3], v[34:35]
    v_pk_add_f32 v[36:37], v[36:37], v[48:49]
    v_pk_add_f32 v[38:39], v[38:39], v[50:51]
    s_sub_u32 s64, s64, 1
    s_cmp_eq_u32 s64, 0
    s_cbranch_scc1 K2_pdones
    v_mfma_f32_16x16x32_bf16 v[48:51], v[70:73], v[4:7], v[64:67]
    s_nop 5
    v_mfma_f32_16x16x16_bf16 v[48:51], v[18:19], v[68:69], v[48:51]
    s_nop 7
    v_exp_f32 v48, v48 clamp
    v_exp_f32 v49, v49 clamp
    v_exp_f32 v50, v50 clamp
    v_exp_f32 v51, v51 clamp
    v_pk_add_f32 v[48:49], v[48:49], s[56:57]
    v_pk_add_f32 v[50:51], v[50:51], s[56:57]
    v_rcp_f32 v48, v48
    v_rcp_f32 v49, v49
    v_rcp_f32 v50, v50
    v_rcp_f32 v51, v51
    s_nop 0
    v_pk_fma_f32 v[32:33], v[48:49], v[4:5], v[32:33]
    v_pk_fma_f32 v[34:35], v[50:51], v[6:7], v[34:35]
    v_pk_add_f32 v[36:37], v[36:37], v[48:49]
    v_pk_add_f32 v[38:39], v[38:39], v[50:51]
    s_sub_u32 s64, s64, 1
    s_cmp_eq_u32 s64, 0
    s_cbranch_scc1 K2_pdones
    v_mfma_f32_16x16x32_bf16 v[48:51], v[70:73], v[8:11], v[64:67]
    s_nop 5
    v_mfma_f32_16x16x16_bf16 v[48:51], v[20:21], v[68:69], v[48:51]
    s_nop 7
    v_exp_f32 v48, v48 clamp
    v_exp_f32 v49, v49 clamp
    v_exp_f32 v50, v50 clamp
    v_exp_f32 v51, v51 clamp
    v_pk_add_f32 v[48:49], v[48:49], s[56:57]
    v_pk_add_f32 v[50:51], v[50:51], s[56:57]
    v_rcp_f32 v48, v48
    v_rcp_f32 v49, v49
    v_rcp_f32 v50, v50
    v_rcp_f32 v51, v51
    s_nop 0
    v_pk_fma_f32 v[32:33], v[48:49], v[8:9], v[32:33]
    v_pk_fma_f32 v[34:35], v[50:51], v[10:11], v[34:35]
    v_pk_add_f32 v[36:37], v[36:37], v[48:49]
    v_pk_add_f32 v[38:39], v[38:39], v[50:51]
    s_sub_u32 s64, s64, 1
    s_cmp_eq_u32 s64, 0
    s_cbranch_scc1 K2_pdones
    v_mfma_f32_16x16x32_bf16 v[48:51], v[70:73], v[12:15], v[64:67]
    s_nop 5
    v_mfma_f32_16x16x16_bf16 v[48:51], v[22:23], v[68:69], v[48:51]
    s_nop 7
    v_exp_f32 v48, v48 clamp
    v_exp_f32 v49, v49 clamp
    v_exp_f32 v50, v50 clamp
    v_exp_f32 v51, v51 clamp
    v_pk_add_f32 v[48:49], v[48:49], s[56:57]
    v_pk_add_f32 v[50:51], v[50:51], s[56:57]
    v_rcp_f32 v48, v48
    v_rcp_f32 v49, v49
    v_rcp_f32 v50, v50
    v_rcp_f32 v51, v51
    s_nop 0
    v_pk_fma_f32 v[32:33], v[48:49], v[12:13], v[32:33]
    v_pk_fma_f32 v[34:35], v[50:51], v[14:15], v[34:35]
    v_pk_add_f32 v[36:37], v[36:37], v[48:49]
    v_pk_add_f32 v[38:39], v[38:39], v[50:51]
    s_sub_u32 s64, s64, 1
    s_cmp_eq_u32 s64, 0
    s_cbranch_scc1 K2_pdones
    s_branch K2_loops
K2_pdones:
    s_branch K2_sgrp
K2_sfin:
    v_mbcnt_lo_u32_b32 v0, -1, 0
    v_mbcnt_hi_u32_b32 v0, -1, v0
    v_and_b32 v1, 15, v0
    v_lshrrev_b32 v2, 4, v0
    s_lshl_b32 s65, s48, 10
    s_add_u32 s65, s65, 41168
    v_lshl_add_u32 v3, v0, 4, s65
    v_lshlrev_b32 v5, 3, v1
    v_lshl_add_u32 v5, v2, 1, v5
    v_lshl_add_u32 v4, v5, 1, s65
    ds_write_b128 v3, v[32:35]
    ds_read2st64_b32 v[8:9], v4 offset0:0 offset1:1
    ds_read2st64_b32 v[10:11], v4 offset0:2 offset1:3
    ds_write_b128 v3, v[36:39]
    ds_read2st64_b32 v[12:13], v4 offset0:0 offset1:1
    ds_read2st64_b32 v[14:15], v4 offset0:2 offset1:3
    s_lshl_b32 s65, s60, 8
    v_add_u32 v3, s65, v5
    v_mov_b32 v6, 0
    v_mov_b32 v7, 0
    ds_read_u16_d16_hi v6, v3 offset:32464
    ds_read_u16_d16_hi v7, v3 offset:32592
    s_waitcnt lgkmcnt(0)
    v_pk_add_f32 v[12:13], v[12:13], v[14:15]
    v_pk_add_f32 v[8:9], v[8:9], v[10:11]
    v_add_f32 v12, v12, v13
    v_rcp_f32 v12, v12
    v_add_f32 v8, v8, v9
    v_fma_f32 v8, v8, v12, v6
    v_max_f32 v8, 0, v8
    v_add_f32 v8, v8, v7
    v_cvt_pk_bf16_f32 v8, v8, v8
    buffer_store_short v8, v3, s[52:55], s77 offen sc1
    s_branch K2_snode
K2_rem0:
    v_add_u32 v5, -16, v5
    v_add_u32 v7, 240, v7
K2_rem:
    v_lshrrev_b32 v10, 16, v66
    ds_add_rtn_u32 v67, v10, v30 offset:0
    v_add_u32 v5, -4, v5
    s_waitcnt lgkmcnt(0)
    v_min_u32 v67, s42, v67
    v_mad_u32_u24 v11, v10, s63, v67
    v_lshrrev_b32 v10, 2, v11
    ds_write_b64 v11, v[64:65] offset:5200
    ds_write_b16 v10, v66 offset:512
    v_cmp_lt_i32 vcc, 0, v5
    s_and_b64 exec, exec, vcc
    s_cbranch_execz K2_rem_end
    buffer_load_dwordx3 v[64:66], v7, s[16:19], 0 offen sc1
    v_add_u32 v7, 48, v7
    s_waitcnt vmcnt(0)
    s_branch K2_rem
K2_done:
K2_done0:
    s_endpgm
K2_end:
.section .rodata,"a"
.p2align 6
.amdhsa_kernel gk2_kernel
  .amdhsa_next_free_vgpr 80
  .amdhsa_next_free_sgpr 80
  .amdhsa_accum_offset 80
  .amdhsa_group_segment_fixed_size 0
  .amdhsa_kernarg_size 96
  .amdhsa_user_sgpr_count 2
  .amdhsa_user_sgpr_kernarg_segment_ptr 1
  .amdhsa_system_sgpr_workgroup_id_x 1
.end_amdhsa_kernel
```
